```python
import torch

def _softmax(x, axis=-1):
    return torch.softmax(x, dim=axis)
def _gelu(x):
    return torch.nn.functional.gelu(x, approximate="tanh")
def _silu(x):
    return torch.nn.functional.silu(x)
def _sigmoid(x):
    return torch.sigmoid(x)
def _layernorm(x, axis=-1, eps=1e-5):
    m = x.mean(dim=axis, keepdim=True)
    v = x.var(dim=axis, keepdim=True, unbiased=False)
    return (x - m) / torch.sqrt(v + eps)
def _scatter_add(tgt, idx, src, axis=0):
    return tgt.clone().index_add_(axis, idx, src)
def _segment_sum(src, seg, n):
    out = torch.zeros((n,) + src.shape[1:], dtype=src.dtype)
    return out.index_add_(0, seg, src)
def _pad(x, pw):
    flat = tuple(v for pair in reversed(pw) for v in pair)
    return torch.nn.functional.pad(x, flat)

kernel_name = 'interleave_layers__gqa_block_cached__dense_activation_silu__decode'

def setup_inputs():

    _w = (lambda a: (lambda t: t.to(torch.bfloat16) if t.is_floating_point() else t)(torch.as_tensor(a)))
    def _A_setup():
        B, Sq, D = 2, 1, 512
        Hq, Hkv, Sk, Dh = 32, 8, 8192, 128
        assert Hq % Hkv == 0, (Hq, Hkv)
        return {
            "x": _w((lambda *s: torch.randn(*s, dtype=torch.bfloat16) * 0.1)(B, Sq, D)),
            "k_cache": _w((lambda *s: torch.randn(*s, dtype=torch.bfloat16) * 0.8)(B, Hkv, Sk, Dh)),
            "v_cache": _w((lambda *s: torch.randn(*s, dtype=torch.bfloat16) * 3.2)(B, Hkv, Sk, Dh)),
            "wq": _w((lambda *s: torch.randn(*s, dtype=torch.bfloat16) * 0.8)(D, Hq * Dh) * (D ** -0.5)),
            "wo": _w((lambda *s: torch.randn(*s, dtype=torch.bfloat16) * 3.2)(Hq * Dh, D) * ((Hq * Dh) ** -0.5)),
        }
    _A_in = _A_setup()

    def _B_setup():
        B, S, D, F = 2, 1, 512, 1792
        return {
            "x": _w((lambda *s: torch.randn(*s, dtype=torch.bfloat16) * 0.1)(B, S, D)),
            "w1": _w((lambda *s: torch.randn(*s, dtype=torch.bfloat16) * 1.6)(D, F) * (D ** -0.5)),
            "w2": _w((lambda *s: torch.randn(*s, dtype=torch.bfloat16) * 0.4)(F, D) * (F ** -0.5)),
        }
    _B_in = _B_setup()

    return {
        "A_x": _A_in["x"],
        "A_k_cache": _A_in["k_cache"],
        "A_v_cache": _A_in["v_cache"],
        "A_wq": _A_in["wq"],
        "A_wo": _A_in["wo"],
        "B_x": _B_in["x"],
        "B_w1": _B_in["w1"],
        "B_w2": _B_in["w2"],
    }

def reference(A_x, A_k_cache, A_v_cache, A_wq, A_wo, B_x, B_w1, B_w2):
    def _A_ref(x, k_cache, v_cache, wq, wo):
        B, Sq, D = x.shape
        Hq, Dh = 32, 128
        Hkv = k_cache.shape[1]
        rep = Hq // Hkv
        q = (lambda x, *d: x.permute(*d))((x @ wq).reshape(B, Sq, Hq, Dh), 0, 2, 1, 3)
        k = (lambda x, n, axis: torch.repeat_interleave(x, n, dim=axis))(k_cache, rep, axis=1)
        v = (lambda x, n, axis: torch.repeat_interleave(x, n, dim=axis))(v_cache, rep, axis=1)
        scores = torch.einsum("bhqd,bhkd->bhqk", q, k) * (Dh ** -0.5)
        p = _softmax(scores, axis=-1)
        o = torch.einsum("bhqk,bhkd->bhqd", p, v)
        return (lambda x, *d: x.permute(*d))(o, 0, 2, 1, 3).reshape(B, Sq, Hq * Dh) @ wo

    def _B_ref(x, w1, w2):
        h = torch.einsum("bsd,df->bsf", x, w1)
        h = _silu(h)
        out = torch.einsum("bsf,fd->bsd", h, w2)
        return out

    x = A_x
    x = x + _A_ref(_layernorm(x, axis=-1), A_k_cache, A_v_cache, A_wq, A_wo)
    x = x + _B_ref(_layernorm(x, axis=-1), B_w1, B_w2)
    x = x + _A_ref(_layernorm(x, axis=-1), A_k_cache, A_v_cache, A_wq, A_wo)
    x = x + _B_ref(_layernorm(x, axis=-1), B_w1, B_w2)
    return x
```

```asm
; @launch grid=(256,1,1) block=(512,1,1) lds=70912
.amdgcn_target "amdgcn-amd-amdhsa--gfx950"
.text
.globl interleave_layers__gqa_block_cached__dense_activation_silu__decode_kernel
.p2align 8
.type interleave_layers__gqa_block_cached__dense_activation_silu__decode_kernel,@function
interleave_layers__gqa_block_cached__dense_activation_silu__decode_kernel:
    s_load_dwordx16 s[4:19], s[0:1], 0
    s_load_dwordx2 s[22:23], s[0:1], 80
    s_load_dwordx2 s[20:21], s[0:1], 64
    s_cmp_ge_u32 s2, 256
    s_cbranch_scc1 Lexit
    v_and_b32 v1, 63, v0
    v_lshrrev_b32 v32, 6, v0
    s_nop 0
    v_readfirstlane_b32 s3, v32
    s_and_b32 s25, s2, 7
    s_lshr_b32 s26, s2, 3
    s_and_b32 s41, s26, 7
    s_lshr_b32 s42, s26, 3
    v_and_b32 v33, 15, v1
    v_lshrrev_b32 v34, 4, v1
    s_mov_b32 s39, 0x20000
    v_lshlrev_b32 v50, 4, v1
    s_cmp_eq_u32 s3, 0
    s_cbranch_scc1 Lw0a
    s_lshr_b32 s27, s26, 4
    s_and_b32 s40, s26, 15
    s_mov_b32 s64, 0
    s_mov_b32 s65, 4096
    s_mov_b32 s66, 8192
    s_mov_b32 s67, 12288
    s_lshl_b32 s58, s27, 3
    s_add_u32 s58, s58, s25
    s_lshl_b32 s58, s58, 21
    s_lshl_b32 s59, s40, 17
    s_add_u32 s58, s58, s59
    s_lshl_b32 s59, s3, 14
    s_add_u32 s58, s58, s59
    s_mov_b32 s30, 16384
    s_mov_b32 s31, 0x20000
    s_mov_b32 s34, 16384
    s_mov_b32 s35, 0x20000
    v_lshlrev_b32 v4, 8, v33
    v_lshl_add_u32 v4, v34, 4, v4
    v_lshlrev_b32 v5, 4, v33
    v_and_b32 v35, 1, v34
    v_lshl_add_u32 v5, v35, 13, v5
    v_lshrrev_b32 v35, 1, v34
    v_lshl_add_u32 v5, v35, 10, v5
    s_waitcnt lgkmcnt(0)
    s_branch Lbs
Lw0a:
    v_lshlrev_b32 v41, 13, v34
    v_lshl_add_u32 v41, v33, 4, v41
    s_lshl_b32 s59, s41, 19
    s_lshl_b32 s60, s25, 10
    s_add_u32 s59, s59, s60
    s_lshl_b32 s60, s42, 8
    s_add_u32 s72, s59, s60
    s_add_u32 s73, s72, 31744
    s_add_u32 s74, s72, 63488
    s_add_u32 s75, s72, 95232
    s_add_u32 s76, s72, 131072
    s_add_u32 s77, s72, 162816
    s_add_u32 s78, s72, 194560
    s_add_u32 s79, s72, 226304
    s_add_u32 s80, s72, 262144
    s_add_u32 s81, s72, 293888
    s_add_u32 s82, s72, 325632
    s_add_u32 s83, s72, 357376
    s_add_u32 s84, s72, 393216
    s_add_u32 s85, s72, 424960
    s_add_u32 s86, s72, 456704
    s_add_u32 s87, s72, 488448
    s_mov_b32 s38, 4194304
    s_mov_b32 m0, 21760
    s_waitcnt lgkmcnt(0)
    s_mov_b32 s36, s10
    s_mov_b32 s37, s11
    buffer_load_dwordx4 v41, s[36:39], s72 offen offset:0 nt lds
    buffer_load_dwordx4 v41, s[36:39], s73 offen offset:1024 nt lds
    buffer_load_dwordx4 v41, s[36:39], s74 offen offset:2048 nt lds
    buffer_load_dwordx4 v41, s[36:39], s75 offen offset:3072 nt lds
    s_mov_b32 m0, 25856
    s_nop 0
    buffer_load_dwordx4 v41, s[36:39], s76 offen offset:0 nt lds
    buffer_load_dwordx4 v41, s[36:39], s77 offen offset:1024 nt lds
    buffer_load_dwordx4 v41, s[36:39], s78 offen offset:2048 nt lds
    buffer_load_dwordx4 v41, s[36:39], s79 offen offset:3072 nt lds
    s_mov_b32 m0, 29952
    s_nop 0
    buffer_load_dwordx4 v41, s[36:39], s80 offen offset:0 nt lds
    buffer_load_dwordx4 v41, s[36:39], s81 offen offset:1024 nt lds
    buffer_load_dwordx4 v41, s[36:39], s82 offen offset:2048 nt lds
    buffer_load_dwordx4 v41, s[36:39], s83 offen offset:3072 nt lds
    s_mov_b32 m0, 34048
    s_nop 0
    buffer_load_dwordx4 v41, s[36:39], s84 offen offset:0 nt lds
    buffer_load_dwordx4 v41, s[36:39], s85 offen offset:1024 nt lds
    buffer_load_dwordx4 v41, s[36:39], s86 offen offset:2048 nt lds
    buffer_load_dwordx4 v41, s[36:39], s87 offen offset:3072 nt lds
    v_and_b32 v40, 3, v1
    v_min_u32 v40, 1, v40
    v_lshlrev_b32 v40, 10, v40
    v_lshl_add_u32 v40, v34, 4, v40
    s_lshl_b32 s61, s41, 7
    v_add_u32 v40, s61, v40
    s_lshr_b32 s27, s26, 4
    s_and_b32 s40, s26, 15
    s_mov_b32 s64, 0
    s_mov_b32 s65, 4096
    s_mov_b32 s66, 8192
    s_mov_b32 s67, 12288
    s_lshl_b32 s58, s27, 3
    s_add_u32 s58, s58, s25
    s_lshl_b32 s58, s58, 21
    s_lshl_b32 s59, s40, 17
    s_add_u32 s58, s58, s59
    s_lshl_b32 s59, s3, 14
    s_add_u32 s58, s58, s59
    s_mov_b32 s30, 16384
    s_mov_b32 s31, 0x20000
    s_mov_b32 s34, 16384
    s_mov_b32 s35, 0x20000
    v_lshlrev_b32 v4, 8, v33
    v_lshl_add_u32 v4, v34, 4, v4
    v_lshlrev_b32 v5, 4, v33
    v_and_b32 v35, 1, v34
    v_lshl_add_u32 v5, v35, 13, v5
    v_lshrrev_b32 v35, 1, v34
    v_lshl_add_u32 v5, v35, 10, v5
    global_load_dwordx4 v[184:187], v40, s[4:5]
    global_load_dwordx4 v[188:191], v40, s[4:5] offset:64
    global_load_dwordx4 v[64:67], v50, s[4:5]
    global_load_dwordx4 v[68:71], v50, s[4:5] offset:1024
    s_add_u32 s28, s6, s58
    s_addc_u32 s29, s7, 0
    s_add_u32 s32, s8, s58
    s_addc_u32 s33, s9, 0
    s_load_dword s24, s[22:23], 0xf000
    buffer_load_dwordx4 a[0:3], v4, s[28:31], s64 offen offset:0 nt
    buffer_load_dwordx4 a[4:7], v4, s[28:31], s64 offen offset:64 nt
    buffer_load_dwordx4 a[8:11], v4, s[28:31], s64 offen offset:128 nt
    buffer_load_dwordx4 a[12:15], v4, s[28:31], s64 offen offset:192 nt
    buffer_load_dwordx4 a[16:19], v4, s[28:31], s65 offen offset:0 nt
    buffer_load_dwordx4 a[20:23], v4, s[28:31], s65 offen offset:64 nt
    buffer_load_dwordx4 a[24:27], v4, s[28:31], s65 offen offset:128 nt
    buffer_load_dwordx4 a[28:31], v4, s[28:31], s65 offen offset:192 nt
    buffer_load_dwordx4 a[32:35], v4, s[28:31], s66 offen offset:0 nt
    buffer_load_dwordx4 a[36:39], v4, s[28:31], s66 offen offset:64 nt
    buffer_load_dwordx4 a[40:43], v4, s[28:31], s66 offen offset:128 nt
    buffer_load_dwordx4 a[44:47], v4, s[28:31], s66 offen offset:192 nt
    buffer_load_dwordx4 a[48:51], v4, s[28:31], s67 offen offset:0 nt
    buffer_load_dwordx4 a[52:55], v4, s[28:31], s67 offen offset:64 nt
    buffer_load_dwordx4 a[56:59], v4, s[28:31], s67 offen offset:128 nt
    buffer_load_dwordx4 a[60:63], v4, s[28:31], s67 offen offset:192 nt
    buffer_load_dwordx4 v[96:99], v5, s[32:35], s64 offen offset:0 nt
    buffer_load_dwordx4 v[100:103], v5, s[32:35], s64 offen offset:256 nt
    buffer_load_dwordx4 v[104:107], v5, s[32:35], s64 offen offset:512 nt
    buffer_load_dwordx4 v[108:111], v5, s[32:35], s64 offen offset:768 nt
    buffer_load_dwordx4 v[112:115], v5, s[32:35], s65 offen offset:0 nt
    buffer_load_dwordx4 v[116:119], v5, s[32:35], s65 offen offset:256 nt
    buffer_load_dwordx4 v[120:123], v5, s[32:35], s65 offen offset:512 nt
    buffer_load_dwordx4 v[124:127], v5, s[32:35], s65 offen offset:768 nt
    buffer_load_dwordx4 v[128:131], v5, s[32:35], s64 offen offset:2048 nt
    buffer_load_dwordx4 v[132:135], v5, s[32:35], s64 offen offset:2304 nt
    buffer_load_dwordx4 v[136:139], v5, s[32:35], s64 offen offset:2560 nt
    buffer_load_dwordx4 v[140:143], v5, s[32:35], s64 offen offset:2816 nt
    buffer_load_dwordx4 v[144:147], v5, s[32:35], s65 offen offset:2048 nt
    buffer_load_dwordx4 v[148:151], v5, s[32:35], s65 offen offset:2304 nt
    buffer_load_dwordx4 v[152:155], v5, s[32:35], s65 offen offset:2560 nt
    buffer_load_dwordx4 v[156:159], v5, s[32:35], s65 offen offset:2816 nt
    s_barrier
    s_branch Lsetup
Lbs:
    s_add_u32 s28, s6, s58
    s_addc_u32 s29, s7, 0
    s_add_u32 s32, s8, s58
    s_addc_u32 s33, s9, 0
    s_load_dword s24, s[22:23], 0xf000
    s_cmp_eq_u32 s3, 4
    s_cbranch_scc0 Lbs2
    v_mov_b32 v40, 0
    v_mov_b32 v41, 0
    v_mov_b32 v42, 0
    v_mov_b32 v43, 0
    ds_write_b128 v50, v[40:43] offset:5376
    ds_write_b128 v50, v[40:43] offset:6400
    ds_write_b128 v50, v[40:43] offset:7424
    s_waitcnt lgkmcnt(0)
Lbs2:
    s_cmp_gt_u32 s3, 3
    s_barrier
    s_cbranch_scc1 Lsetup
    buffer_load_dwordx4 a[0:3], v4, s[28:31], s64 offen offset:0 nt
    buffer_load_dwordx4 a[4:7], v4, s[28:31], s64 offen offset:64 nt
    buffer_load_dwordx4 a[8:11], v4, s[28:31], s64 offen offset:128 nt
    buffer_load_dwordx4 a[12:15], v4, s[28:31], s64 offen offset:192 nt
    buffer_load_dwordx4 a[16:19], v4, s[28:31], s65 offen offset:0 nt
    buffer_load_dwordx4 a[20:23], v4, s[28:31], s65 offen offset:64 nt
    buffer_load_dwordx4 a[24:27], v4, s[28:31], s65 offen offset:128 nt
    buffer_load_dwordx4 a[28:31], v4, s[28:31], s65 offen offset:192 nt
    buffer_load_dwordx4 a[32:35], v4, s[28:31], s66 offen offset:0 nt
    buffer_load_dwordx4 a[36:39], v4, s[28:31], s66 offen offset:64 nt
    buffer_load_dwordx4 a[40:43], v4, s[28:31], s66 offen offset:128 nt
    buffer_load_dwordx4 a[44:47], v4, s[28:31], s66 offen offset:192 nt
    buffer_load_dwordx4 a[48:51], v4, s[28:31], s67 offen offset:0 nt
    buffer_load_dwordx4 a[52:55], v4, s[28:31], s67 offen offset:64 nt
    buffer_load_dwordx4 a[56:59], v4, s[28:31], s67 offen offset:128 nt
    buffer_load_dwordx4 a[60:63], v4, s[28:31], s67 offen offset:192 nt
    s_nop 0
    buffer_load_dwordx4 v[96:99], v5, s[32:35], s64 offen offset:0 nt
    buffer_load_dwordx4 v[100:103], v5, s[32:35], s64 offen offset:256 nt
    buffer_load_dwordx4 v[104:107], v5, s[32:35], s64 offen offset:512 nt
    buffer_load_dwordx4 v[108:111], v5, s[32:35], s64 offen offset:768 nt
    buffer_load_dwordx4 v[112:115], v5, s[32:35], s65 offen offset:0 nt
    buffer_load_dwordx4 v[116:119], v5, s[32:35], s65 offen offset:256 nt
    buffer_load_dwordx4 v[120:123], v5, s[32:35], s65 offen offset:512 nt
    buffer_load_dwordx4 v[124:127], v5, s[32:35], s65 offen offset:768 nt
    buffer_load_dwordx4 v[128:131], v5, s[32:35], s64 offen offset:2048 nt
    buffer_load_dwordx4 v[132:135], v5, s[32:35], s64 offen offset:2304 nt
    buffer_load_dwordx4 v[136:139], v5, s[32:35], s64 offen offset:2560 nt
    buffer_load_dwordx4 v[140:143], v5, s[32:35], s64 offen offset:2816 nt
    buffer_load_dwordx4 v[144:147], v5, s[32:35], s65 offen offset:2048 nt
    buffer_load_dwordx4 v[148:151], v5, s[32:35], s65 offen offset:2304 nt
    buffer_load_dwordx4 v[152:155], v5, s[32:35], s65 offen offset:2560 nt
    buffer_load_dwordx4 v[156:159], v5, s[32:35], s65 offen offset:2816 nt
Lsetup:
    s_mov_b32 s36, s12
    s_mov_b32 s37, s13
    s_mov_b32 s38, 4194304
    s_mov_b32 s44, 0xffffff00
    s_mov_b32 s6, 0xff
    s_mov_b32 s8, 0x00ff00ff
    s_mov_b32 s9, 0x00ff00ff
    s_mov_b32 s40, 0x33800000
    v_mov_b32 v61, 0x4b800000
    s_mov_b32 s46, 0
    s_mov_b32 s45, 0
    s_getreg_b32 s48, hwreg(HW_REG_XCC_ID)
    s_and_b32 s48, s48, 0xf
    s_mov_b32 s50, s22
    s_mov_b32 s51, s23
    s_add_u32 s52, s22, 262144
    s_addc_u32 s53, s23, 0
    s_mov_b32 s84, s22
    s_mov_b32 s85, s23
    s_mov_b32 s86, 0x400000
    s_mov_b32 s87, 0x20000
    s_mov_b32 s54, 0x05040100
    s_mov_b32 s55, 0x07060302
    s_mov_b32 s56, 0x44444444
    s_mov_b32 s57, 0x44444444
    v_mov_b32 v6, 0x3f803f80
    v_mov_b32 v7, 0x4444
    v_mov_b32 v35, 0xeeee
    s_nop 1
    v_mov_b32_dpp v7, v35 quad_perm:[0,1,2,3] row_mask:0xf bank_mask:0xa
    s_and_b32 s59, s3, 1
    s_lshl_b32 s59, s59, 2
    s_add_u32 s59, s59, s42
    s_cmp_eq_u32 s59, 7
    s_cselect_b32 s62, 0, -1
    v_lshlrev_b32 v27, 2, v1
    v_and_b32 v37, 7, v1
    v_lshrrev_b32 v38, 3, v1
    s_lshl_b32 s58, s25, 16
    v_and_b32 v39, 31, v1
    v_lshrrev_b32 v40, 5, v1
    v_lshlrev_b32 v41, 4, v39
    v_lshl_add_u32 v41, v40, 13, v41
    s_lshl_b32 s59, s27, 14
    s_add_u32 s59, s59, s58
    s_lshl_b32 s60, s3, 9
    s_add_u32 s59, s59, s60
    s_add_u32 s59, s59, 4096
    v_add_u32 v10, s59, v41
    s_lshl_b32 s59, s27, 4
    s_add_u32 s59, s59, s58
    s_add_u32 s59, s59, 49152
    v_lshl_add_u32 v11, v37, 5, s59
    v_lshlrev_b32 v41, 3, v39
    v_lshl_add_u32 v41, v40, 2, v41
    s_mul_i32 s59, s3, 288
    s_add_u32 s59, s59, 144
    v_add_u32 v24, s59, v41
    v_and_b32 v41, 3, v1
    v_mul_u32_u24 v42, 288, v41
    v_lshl_add_u32 v42, v34, 4, v42
    v_add_u32 v25, 144, v42
    s_lshl_b32 s59, s3, 11
    s_add_u32 s59, s59, 5376
    v_add_u32 v26, s59, v50
    v_lshlrev_b32 v28, 5, v41
    s_lshl_b32 s59, s3, 8
    v_add_u32 v8, s59, v27
    s_and_b32 s63, s3, 3
    s_lshl_b32 s60, s63, 9
    s_add_u32 s59, s60, 5376
    v_lshl_add_u32 v42, v39, 4, s59
    v_lshl_add_u32 v9, v40, 13, v42
    s_lshl_b32 s59, s26, 11
    s_add_u32 s59, s59, s58
    s_add_u32 s59, s59, s60
    s_add_u32 s59, s59, 524288
    v_lshl_add_u32 v42, v39, 4, s59
    v_lshl_add_u32 v12, v40, 3, v42
    s_lshl_b32 s59, s25, 10
    s_lshl_b32 s60, s26, 5
    s_add_u32 s60, s60, s59
    s_add_u32 s60, s60, 1048576
    v_lshl_add_u32 v13, v1, 3, s60
    s_lshr_b32 s60, s3, 1
    s_lshl_b32 s61, s60, 9
    s_add_u32 s59, s59, s61
    s_add_u32 s59, s59, 1048576
    v_lshl_add_u32 v15, v1, 3, s59
    s_lshl_b32 s59, s60, 15
    s_add_u32 s59, s59, s58
    s_lshl_b32 s61, s42, 9
    s_add_u32 s59, s59, s61
    s_and_b32 s61, s3, 1
    s_lshl_b32 s49, s61, 8
    s_add_u32 s59, s59, s49
    s_add_u32 s59, s59, 528384
    v_lshlrev_b32 v42, 4, v33
    v_lshl_add_u32 v42, v34, 13, v42
    v_add_u32 v14, s59, v42
    s_mul_i32 s59, s60, 320
    s_lshl_b32 s61, s61, 7
    s_add_u32 s59, s59, s61
    s_add_u32 s59, s59, 2448
    v_lshlrev_b32 v42, 3, v33
    v_lshl_add_u32 v42, v34, 1, v42
    v_add_u32 v16, s59, v42
    v_bfe_u32 v42, v33, 2, 1
    v_mul_u32_u24 v53, 192, v42
    v_lshl_add_u32 v53, v34, 4, v53
    v_mul_u32_u24 v42, 320, v42
    v_lshl_add_u32 v42, v34, 4, v42
    v_add_u32 v0, 2448, v42
    s_lshl_b32 s59, s25, 2
    s_add_u32 s59, s59, s42
    s_lshl_b32 s61, s59, 13
    s_and_b32 s60, s59, 16
    s_add_u32 s59, s59, s60
    s_lshl_b32 s59, s59, 9
    s_lshl_b32 s60, s41, 15
    s_add_u32 s59, s59, s60
    s_add_u32 s49, s59, 2097152
    v_lshl_add_u32 v59, v39, 4, s49
    v_mul_u32_u24 v45, 262144, v40
    v_add_u32 v59, v59, v45
    s_lshl_b32 s63, s63, 6
    s_add_u32 s59, s59, s63
    s_add_u32 s59, s59, 2097152
    v_lshl_add_u32 v22, v33, 2, s59
    v_and_b32 v43, 1, v34
    v_lshl_add_u32 v22, v43, 8, v22
    v_lshl_add_u32 v22, v40, 13, v22
    s_lshl_b32 s59, s41, 8
    s_add_u32 s59, s59, s61
    s_add_u32 s59, s59, s63
    s_add_u32 s59, s59, 1114112
    v_lshl_add_u32 v18, v33, 2, s59
    v_lshl_add_u32 v18, v34, 11, v18
    s_lshr_b32 s59, s3, 1
    s_and_b32 s63, s3, 1
    v_lshlrev_b32 v42, 4, v37
    v_and_b32 v43, 4, v38
    v_add_u32 v43, v43, v38
    v_lshl_add_u32 v43, v43, 11, v42
    s_lshl_b32 s49, s3, 7
    s_add_u32 s60, s60, s49
    s_add_u32 s60, s60, 2097152
    v_add_u32 v17, s60, v43
    v_lshl_add_u32 v43, v38, 8, v42
    s_lshl_b32 s49, s63, 7
    s_add_u32 s60, s61, s49
    s_add_u32 s60, s60, 1116160
    v_add_u32 v20, s60, v43
    s_lshl_b32 s49, s59, 11
    v_add_u32 v62, s49, v20
    s_lshl_b32 s49, s59, 4
    s_add_u32 s60, s61, s49
    s_add_u32 s60, s60, 1120256
    v_lshl_add_u32 v21, v37, 5, s60
    v_lshl_add_u32 v43, v37, 2, v34
    v_lshlrev_b32 v43, 1, v43
    s_mul_i32 s60, s59, 192
    s_lshl_b32 s49, s63, 6
    s_add_u32 s60, s60, s49
    s_add_u32 s60, s60, 1296
    v_add_u32 v29, s60, v43
    v_lshrrev_b32 v43, 2, v33
    v_min_u32 v43, 2, v43
    v_mul_u32_u24 v43, 192, v43
    v_lshl_add_u32 v43, v34, 4, v43
    v_add_u32 v30, 1296, v43
    v_bfe_u32 v43, v1, 2, 2
    v_lshl_add_u32 v43, v34, 3, v43
    v_lshlrev_b32 v47, 3, v41
    v_lshl_add_u32 v31, v43, 7, v47
    v_lshl_add_u32 v47, v43, 8, v47
    s_add_u32 s60, s61, 1120256
    s_add_u32 s49, s58, 49152
    s_cmp_eq_u32 s3, 4
    s_cselect_b32 s60, s60, s49
    s_lshl_b32 s49, s41, 5
    s_add_u32 s60, s60, s49
    v_and_b32 v43, 3, v33
    v_add_u32 v43, 1, v43
    v_lshrrev_b32 v44, 3, v33
    s_mov_b32 vcc_lo, 0x01100101
    s_mov_b32 vcc_hi, 0
    v_cndmask_b32 v43, v43, v44, vcc
    v_lshl_add_u32 v43, v34, 2, v43
    v_lshl_add_u32 v19, v43, 2, s60
    s_lshl_b32 s59, s41, 11
    s_add_u32 s59, s59, s58
    s_lshl_b32 s60, s42, 9
    s_add_u32 s59, s59, s60
    s_lshl_b32 s60, s3, 6
    s_add_u32 s59, s59, s60
    s_add_u32 s59, s59, 0
    v_lshl_add_u32 v23, v33, 2, s59
    v_lshl_add_u32 v23, v34, 14, v23
    v_and_b32 v43, 3, v38
    v_lshlrev_b32 v56, 17, v43
    v_lshl_add_u32 v56, v40, 13, v56
    v_add_u32 v56, v56, v42
    v_mul_u32_u24 v57, 3584, v38
    v_add_u32 v57, v57, v42
    v_lshl_add_u32 v58, v38, 10, v42
    s_and_b32 s63, s3, 3
    s_lshl_b32 s59, s41, 2
    s_add_u32 s59, s59, s63
    s_mul_i32 s59, s59, 57344
    s_mul_i32 s60, s25, 448
    s_add_u32 s59, s59, s60
    s_lshl_b32 s60, s42, 7
    s_add_u32 s14, s59, s60
    s_mul_i32 s59, s25, 229376
    s_lshl_b32 s60, s42, 16
    s_add_u32 s59, s59, s60
    s_lshl_b32 s60, s63, 14
    s_add_u32 s59, s59, s60
    s_lshl_b32 s60, s41, 7
    s_add_u32 s15, s59, s60
    s_lshr_b32 s10, s2, 4
    s_lshl_b32 s10, s10, 14
    s_and_b32 s60, s2, 15
    s_lshl_b32 s60, s60, 9
    s_add_u32 s10, s10, s60
    s_add_u32 s10, s10, 3145728
    s_and_b32 s59, s3, 1
    s_lshl_b32 s59, s59, 13
    s_and_b32 s60, s3, 2
    s_lshl_b32 s60, s60, 6
    s_add_u32 s59, s59, s60
    s_add_u32 s59, s59, s10
    s_add_u32 s12, s22, s59
    s_addc_u32 s13, s23, 0
    s_waitcnt lgkmcnt(0)
    s_and_b32 s43, s24, 0xff
    s_cmp_eq_u32 s43, 0xff
    s_cselect_b32 s43, 0, s43
    s_add_u32 s43, s43, 1
    v_mov_b32 v2, s43
    s_mul_i32 s59, s43, 0x01010101
    v_mov_b32 v60, s59
    s_cmp_gt_u32 s3, 3
    s_cbranch_scc1 Lm0
    s_cmp_eq_u32 s3, 0
    s_cbranch_scc0 Lg0
    s_waitcnt vmcnt(32)
    s_lshl_b32 s59, s41, 3
    s_lshl_b64 exec, 0xff, s59
    v_and_b32 v36, 0x70, v50
    ds_write_b128 v36, v[64:67] offset:1296
    ds_write_b128 v36, v[68:71] offset:1488
    s_mov_b64 exec, -1
    v_dot2_f32_bf16 v32, v64, v6, 0
    v_dot2_f32_bf16 v33, v64, v64, 0
    v_dot2_f32_bf16 v32, v65, v6, v32
    v_dot2_f32_bf16 v33, v65, v65, v33
    v_dot2_f32_bf16 v32, v66, v6, v32
    v_dot2_f32_bf16 v33, v66, v66, v33
    v_dot2_f32_bf16 v32, v67, v6, v32
    v_dot2_f32_bf16 v33, v67, v67, v33
    v_dot2_f32_bf16 v34, v68, v6, 0
    v_dot2_f32_bf16 v35, v68, v68, 0
    v_dot2_f32_bf16 v34, v69, v6, v34
    v_dot2_f32_bf16 v35, v69, v69, v35
    v_dot2_f32_bf16 v34, v70, v6, v34
    v_dot2_f32_bf16 v35, v70, v70, v35
    v_dot2_f32_bf16 v34, v71, v6, v34
    v_dot2_f32_bf16 v35, v71, v71, v35
    s_nop 2
    ds_read_b64_tr_b16 v[64:65], v47 offset:21760
    ds_read_b64_tr_b16 v[66:67], v47 offset:22784
    ds_read_b64_tr_b16 v[68:69], v47 offset:29952
    ds_read_b64_tr_b16 v[70:71], v47 offset:30976
    ds_read_b64_tr_b16 v[72:73], v47 offset:21792
    ds_read_b64_tr_b16 v[74:75], v47 offset:22816
    ds_read_b64_tr_b16 v[76:77], v47 offset:29984
    ds_read_b64_tr_b16 v[78:79], v47 offset:31008
    ds_read_b64_tr_b16 v[80:81], v47 offset:21824
    ds_read_b64_tr_b16 v[82:83], v47 offset:22848
    ds_read_b64_tr_b16 v[84:85], v47 offset:30016
    ds_read_b64_tr_b16 v[86:87], v47 offset:31040
    ds_read_b64_tr_b16 v[88:89], v47 offset:21856
    ds_read_b64_tr_b16 v[90:91], v47 offset:22880
    ds_read_b64_tr_b16 v[92:93], v47 offset:30048
    ds_read_b64_tr_b16 v[94:95], v47 offset:31072
    v_permlane32_swap_b32 v32, v34
    v_permlane32_swap_b32 v33, v35
    v_add_f32 v32, v32, v34
    v_add_f32 v33, v33, v35
    s_nop 1
    v_permlane16_swap_b32 v32, v33
    v_add_f32 v32, v32, v33
    s_nop 1
    v_add_f32_dpp v32, v32, v32 row_ror:8 row_mask:0xf bank_mask:0xf
    s_nop 1
    v_add_f32_dpp v32, v32, v32 row_ror:4 row_mask:0xf bank_mask:0xf
    s_nop 1
    v_add_f32_dpp v32, v32, v32 row_ror:2 row_mask:0xf bank_mask:0xf
    s_nop 1
    v_add_f32_dpp v32, v32, v32 row_ror:1 row_mask:0xf bank_mask:0xf
    s_nop 0
    v_readlane_b32 s88, v32, 0
    v_readlane_b32 s89, v32, 16
    v_readlane_b32 s90, v32, 32
    v_readlane_b32 s91, v32, 48
    s_mov_b32 vcc_lo, 0x11111111
    s_mov_b32 vcc_hi, 0x11111111
    v_mov_b32 v33, s90
    v_mov_b32 v34, s91
    v_mov_b32 v35, s88
    v_mov_b32 v36, s89
    v_cndmask_b32 v33, v33, v35, vcc
    v_cndmask_b32 v34, v34, v36, vcc
    v_mul_f32 v33, 0x3b000000, v33
    v_mul_f32 v34, 0x3b000000, v34
    v_fma_f32 v34, -v33, v33, v34
    v_max_f32 v34, 0, v34
    v_add_f32 v34, 0x3727c5ac, v34
    v_rsq_f32 v34, v34
    v_lshlrev_b32 v36, 16, v184
    v_and_b32 v37, 0xffff0000, v184
    v_sub_f32 v36, v36, v33
    v_sub_f32 v37, v37, v33
    v_mul_f32 v36, v36, v34
    v_mul_f32 v37, v37, v34
    v_cvt_pk_bf16_f32 v184, v36, v37
    v_cndmask_b32 v184, v184, v6, s[56:57]
    v_lshlrev_b32 v36, 16, v185
    v_and_b32 v37, 0xffff0000, v185
    v_sub_f32 v36, v36, v33
    v_sub_f32 v37, v37, v33
    v_mul_f32 v36, v36, v34
    v_mul_f32 v37, v37, v34
    v_cvt_pk_bf16_f32 v185, v36, v37
    v_cndmask_b32 v185, v185, v6, s[56:57]
    v_lshlrev_b32 v36, 16, v186
    v_and_b32 v37, 0xffff0000, v186
    v_sub_f32 v36, v36, v33
    v_sub_f32 v37, v37, v33
    v_mul_f32 v36, v36, v34
    v_mul_f32 v37, v37, v34
    v_cvt_pk_bf16_f32 v186, v36, v37
    v_cndmask_b32 v186, v186, v6, s[56:57]
    v_lshlrev_b32 v36, 16, v187
    v_and_b32 v37, 0xffff0000, v187
    v_sub_f32 v36, v36, v33
    v_sub_f32 v37, v37, v33
    v_mul_f32 v36, v36, v34
    v_mul_f32 v37, v37, v34
    v_cvt_pk_bf16_f32 v187, v36, v37
    v_cndmask_b32 v187, v187, v6, s[56:57]
    v_lshlrev_b32 v36, 16, v188
    v_and_b32 v37, 0xffff0000, v188
    v_sub_f32 v36, v36, v33
    v_sub_f32 v37, v37, v33
    v_mul_f32 v36, v36, v34
    v_mul_f32 v37, v37, v34
    v_cvt_pk_bf16_f32 v188, v36, v37
    v_cndmask_b32 v188, v188, v6, s[56:57]
    v_lshlrev_b32 v36, 16, v189
    v_and_b32 v37, 0xffff0000, v189
    v_sub_f32 v36, v36, v33
    v_sub_f32 v37, v37, v33
    v_mul_f32 v36, v36, v34
    v_mul_f32 v37, v37, v34
    v_cvt_pk_bf16_f32 v189, v36, v37
    v_cndmask_b32 v189, v189, v6, s[56:57]
    v_lshlrev_b32 v36, 16, v190
    v_and_b32 v37, 0xffff0000, v190
    v_sub_f32 v36, v36, v33
    v_sub_f32 v37, v37, v33
    v_mul_f32 v36, v36, v34
    v_mul_f32 v37, v37, v34
    v_cvt_pk_bf16_f32 v190, v36, v37
    v_cndmask_b32 v190, v190, v6, s[56:57]
    v_lshlrev_b32 v36, 16, v191
    v_and_b32 v37, 0xffff0000, v191
    v_sub_f32 v36, v36, v33
    v_sub_f32 v37, v37, v33
    v_mul_f32 v36, v36, v34
    v_mul_f32 v37, v37, v34
    v_cvt_pk_bf16_f32 v191, v36, v37
    v_cndmask_b32 v191, v191, v6, s[56:57]
    s_mov_b32 vcc_lo, 0x11111111
    s_mov_b32 vcc_hi, 0x11111111
    v_mov_b32 v45, s44
    v_cndmask_b32 v44, -1, v45, vcc
    v_cndmask_b32 v45, 0, v2, vcc
    s_waitcnt lgkmcnt(0)
    v_mfma_f32_16x16x32_bf16 v[160:163], v[184:187], v[64:67], 0
    v_mfma_f32_16x16x32_bf16 v[164:167], v[184:187], v[72:75], 0
    v_mfma_f32_16x16x32_bf16 v[168:171], v[184:187], v[80:83], 0
    v_mfma_f32_16x16x32_bf16 v[172:175], v[184:187], v[88:91], 0
    v_mfma_f32_16x16x32_bf16 v[160:163], v[188:191], v[68:71], v[160:163]
    v_mfma_f32_16x16x32_bf16 v[164:167], v[188:191], v[76:79], v[164:167]
    v_mfma_f32_16x16x32_bf16 v[168:171], v[188:191], v[84:87], v[168:171]
    v_mfma_f32_16x16x32_bf16 v[172:175], v[188:191], v[92:95], v[172:175]
    s_nop 1
    ds_read_b64_tr_b16 v[64:65], v47 offset:21888
    ds_read_b64_tr_b16 v[66:67], v47 offset:22912
    ds_read_b64_tr_b16 v[68:69], v47 offset:30080
    ds_read_b64_tr_b16 v[70:71], v47 offset:31104
    ds_read_b64_tr_b16 v[72:73], v47 offset:21920
    ds_read_b64_tr_b16 v[74:75], v47 offset:22944
    ds_read_b64_tr_b16 v[76:77], v47 offset:30112
    ds_read_b64_tr_b16 v[78:79], v47 offset:31136
    ds_read_b64_tr_b16 v[80:81], v47 offset:21952
    ds_read_b64_tr_b16 v[82:83], v47 offset:22976
    ds_read_b64_tr_b16 v[84:85], v47 offset:30144
    ds_read_b64_tr_b16 v[86:87], v47 offset:31168
    ds_read_b64_tr_b16 v[88:89], v47 offset:21984
    ds_read_b64_tr_b16 v[90:91], v47 offset:23008
    ds_read_b64_tr_b16 v[92:93], v47 offset:30176
    ds_read_b64_tr_b16 v[94:95], v47 offset:31200
    v_mov_b32_dpp v160, v164 quad_perm:[0,1,2,3] row_mask:0x2 bank_mask:0xf
    v_mov_b32_dpp v161, v165 quad_perm:[0,1,2,3] row_mask:0x2 bank_mask:0xf
    v_mov_b32_dpp v162, v166 quad_perm:[0,1,2,3] row_mask:0x2 bank_mask:0xf
    v_mov_b32_dpp v160, v168 quad_perm:[0,1,2,3] row_mask:0x4 bank_mask:0xf
    v_mov_b32_dpp v161, v169 quad_perm:[0,1,2,3] row_mask:0x4 bank_mask:0xf
    v_mov_b32_dpp v162, v170 quad_perm:[0,1,2,3] row_mask:0x4 bank_mask:0xf
    v_mov_b32_dpp v160, v172 quad_perm:[0,1,2,3] row_mask:0x8 bank_mask:0xf
    v_mov_b32_dpp v161, v173 quad_perm:[0,1,2,3] row_mask:0x8 bank_mask:0xf
    v_mov_b32_dpp v162, v174 quad_perm:[0,1,2,3] row_mask:0x8 bank_mask:0xf
    v_and_or_b32 v32, v160, v44, v45
    v_and_or_b32 v33, v161, v44, v45
    v_and_or_b32 v34, v162, v44, v45
    ds_write_b128 v50, v[32:35] offset:5376
    s_waitcnt lgkmcnt(0)
    v_mfma_f32_16x16x32_bf16 v[160:163], v[184:187], v[64:67], 0
    v_mfma_f32_16x16x32_bf16 v[164:167], v[184:187], v[72:75], 0
    v_mfma_f32_16x16x32_bf16 v[168:171], v[184:187], v[80:83], 0
    v_mfma_f32_16x16x32_bf16 v[172:175], v[184:187], v[88:91], 0
    v_mfma_f32_16x16x32_bf16 v[160:163], v[188:191], v[68:71], v[160:163]
    v_mfma_f32_16x16x32_bf16 v[164:167], v[188:191], v[76:79], v[164:167]
    v_mfma_f32_16x16x32_bf16 v[168:171], v[188:191], v[84:87], v[168:171]
    v_mfma_f32_16x16x32_bf16 v[172:175], v[188:191], v[92:95], v[172:175]
    s_nop 3
    v_mov_b32_dpp v160, v164 quad_perm:[0,1,2,3] row_mask:0x2 bank_mask:0xf
    v_mov_b32_dpp v161, v165 quad_perm:[0,1,2,3] row_mask:0x2 bank_mask:0xf
    v_mov_b32_dpp v162, v166 quad_perm:[0,1,2,3] row_mask:0x2 bank_mask:0xf
    v_mov_b32_dpp v160, v168 quad_perm:[0,1,2,3] row_mask:0x4 bank_mask:0xf
    v_mov_b32_dpp v161, v169 quad_perm:[0,1,2,3] row_mask:0x4 bank_mask:0xf
    v_mov_b32_dpp v162, v170 quad_perm:[0,1,2,3] row_mask:0x4 bank_mask:0xf
    v_mov_b32_dpp v160, v172 quad_perm:[0,1,2,3] row_mask:0x8 bank_mask:0xf
    v_mov_b32_dpp v161, v173 quad_perm:[0,1,2,3] row_mask:0x8 bank_mask:0xf
    v_mov_b32_dpp v162, v174 quad_perm:[0,1,2,3] row_mask:0x8 bank_mask:0xf
    v_and_or_b32 v32, v160, v44, v45
    v_and_or_b32 v33, v161, v44, v45
    v_and_or_b32 v34, v162, v44, v45
    ds_write_b128 v50, v[32:35] offset:6400
    s_lshl_b32 s59, s48, 8
    s_or_b32 s59, s59, s43
    v_mov_b32 v36, s59
    v_mov_b32 v40, 0x427fff58
    v_mov_b32 v41, 0
    s_mov_b64 vcc, 3
    v_cndmask_b32 v40, v36, v40, vcc
    v_cndmask_b32 v41, v36, v41, vcc
    v_cndmask_b32 v42, v36, v60, vcc
    v_cndmask_b32 v43, v36, v60, vcc
    ds_write_b128 v50, v[40:43] offset:7424
Lg0:
    s_and_b32 s59, s3, 1
    s_lshl_b32 s59, s59, 6
    s_lshr_b32 s60, s3, 1
    s_add_u32 s59, s59, s60
    s_lshl_b32 s60, s25, 9
    s_add_u32 s59, s59, s60
    s_lshl_b32 s60, s42, 1
    s_add_u32 s59, s59, s60
    s_lshl_b32 s59, s59, 10
    s_lshl_b32 s60, s41, 7
    s_add_u32 s64, s59, s60
    s_add_u32 s65, s64, 15360
    s_add_u32 s66, s64, 30720
    s_add_u32 s67, s64, 46080
    v_and_b32 v39, 0xfffff800, v12
    s_lshl_b32 s59, s3, 10
    v_add3_u32 v59, v39, v50, s59
    s_cmp_lt_u32 s3, 2
    s_cbranch_scc1 Lpw2
    v_lshrrev_b32 v40, 4, v1
    v_min_u32 v40, 2, v40
    v_lshlrev_b32 v40, 11, v40
    v_and_b32 v41, 0xf0, v50
    v_readfirstlane_b32 s59, v18
    s_nop 0
    s_and_b32 s59, s59, 0xffffff00
    v_add3_u32 v59, v40, v41, s59
    s_cmp_eq_u32 s3, 2
    s_cbranch_scc1 Lpw2
    s_lshl_b32 s59, s25, 10
    s_add_u32 s59, s59, 1048576
    v_and_b32 v38, 0x1f0, v50
    v_lshl_add_u32 v40, v38, 1, s59
    v_and_b32 v41, 0xffffffe0, v21
    s_mov_b32 vcc_lo, 0
    s_mov_b32 vcc_hi, -1
    v_cndmask_b32 v59, v40, v41, vcc
Lpw2:
    s_waitcnt vmcnt(0)
    v_perm_b32 v64, v100, v96, s54
    v_perm_b32 v65, v108, v104, s54
    v_perm_b32 v66, v116, v112, s54
    v_perm_b32 v67, v124, v120, s54
    v_perm_b32 v72, v100, v96, s55
    v_perm_b32 v73, v108, v104, s55
    v_perm_b32 v74, v116, v112, s55
    v_perm_b32 v75, v124, v120, s55
    v_perm_b32 v80, v101, v97, s54
    v_perm_b32 v81, v109, v105, s54
    v_perm_b32 v82, v117, v113, s54
    v_perm_b32 v83, v125, v121, s54
    v_perm_b32 v88, v101, v97, s55
    v_perm_b32 v89, v109, v105, s55
    v_perm_b32 v90, v117, v113, s55
    v_perm_b32 v91, v125, v121, s55
    v_perm_b32 v160, v102, v98, s54
    v_perm_b32 v161, v110, v106, s54
    v_perm_b32 v162, v118, v114, s54
    v_perm_b32 v163, v126, v122, s54
    v_perm_b32 v164, v102, v98, s55
    v_perm_b32 v165, v110, v106, s55
    v_perm_b32 v166, v118, v114, s55
    v_perm_b32 v167, v126, v122, s55
    v_perm_b32 v168, v103, v99, s54
    v_perm_b32 v169, v111, v107, s54
    v_perm_b32 v170, v119, v115, s54
    v_perm_b32 v171, v127, v123, s54
    v_perm_b32 v172, v103, v99, s55
    v_perm_b32 v173, v111, v107, s55
    v_perm_b32 v174, v119, v115, s55
    v_perm_b32 v175, v127, v123, s55
    v_mov_b32 v96, v160
    v_mov_b32 v97, v161
    v_mov_b32 v98, v162
    v_mov_b32 v99, v163
    v_mov_b32 v104, v164
    v_mov_b32 v105, v165
    v_mov_b32 v106, v166
    v_mov_b32 v107, v167
    v_mov_b32 v112, v168
    v_mov_b32 v113, v169
    v_mov_b32 v114, v170
    v_mov_b32 v115, v171
    v_mov_b32 v120, v172
    v_mov_b32 v121, v173
    v_mov_b32 v122, v174
    v_mov_b32 v123, v175
    v_perm_b32 v68, v132, v128, s54
    v_perm_b32 v69, v140, v136, s54
    v_perm_b32 v70, v148, v144, s54
    v_perm_b32 v71, v156, v152, s54
    v_perm_b32 v76, v132, v128, s55
    v_perm_b32 v77, v140, v136, s55
    v_perm_b32 v78, v148, v144, s55
    v_perm_b32 v79, v156, v152, s55
    v_perm_b32 v84, v133, v129, s54
    v_perm_b32 v85, v141, v137, s54
    v_perm_b32 v86, v149, v145, s54
    v_perm_b32 v87, v157, v153, s54
    v_perm_b32 v92, v133, v129, s55
    v_perm_b32 v93, v141, v137, s55
    v_perm_b32 v94, v149, v145, s55
    v_perm_b32 v95, v157, v153, s55
    v_perm_b32 v100, v134, v130, s54
    v_perm_b32 v101, v142, v138, s54
    v_perm_b32 v102, v150, v146, s54
    v_perm_b32 v103, v158, v154, s54
    v_perm_b32 v108, v134, v130, s55
    v_perm_b32 v109, v142, v138, s55
    v_perm_b32 v110, v150, v146, s55
    v_perm_b32 v111, v158, v154, s55
    v_perm_b32 v116, v135, v131, s54
    v_perm_b32 v117, v143, v139, s54
    v_perm_b32 v118, v151, v147, s54
    v_perm_b32 v119, v159, v155, s54
    v_perm_b32 v124, v135, v131, s55
    v_perm_b32 v125, v143, v139, s55
    v_perm_b32 v126, v151, v147, s55
    v_perm_b32 v127, v159, v155, s55
    v_mov_b32 v152, 0
    v_mov_b32 v153, 0
    v_mov_b32 v154, 0
    v_mov_b32 v155, 0
    v_mov_b32 v156, 0
    v_mov_b32 v157, 0
    v_mov_b32 v158, 0
    v_mov_b32 v159, 0
    s_mov_b32 vcc_lo, 0x11111111
    s_mov_b32 vcc_hi, 0x11111111
    v_mov_b32 v58, s44
    v_cndmask_b32 v57, -1, v58, vcc
    v_cndmask_b32 v58, 0, v2, vcc
    v_mov_b32 v148, 0x3b000000
    v_mov_b32 v3, 0
    v_mov_b32 v4, 0
    v_mov_b32 v5, 0
    s_setprio 3
    v_mov_b32 v128, 0
    v_mov_b32 v129, 0
    v_mov_b32 v130, 0
    v_mov_b32 v131, 0
    v_mov_b32 v132, 0
    v_mov_b32 v133, 0
    v_mov_b32 v134, 0
    v_mov_b32 v135, 0
    v_mov_b32 v136, 0
    v_mov_b32 v137, 0
    v_mov_b32 v138, 0
    v_mov_b32 v139, 0
    v_mov_b32 v140, 0
    v_mov_b32 v141, 0
    v_mov_b32 v142, 0
    v_mov_b32 v143, 0
    s_waitcnt lgkmcnt(0)
    s_barrier
    s_mov_b32 s47, 200000
    global_load_dwordx4 v[48:51], v11, s[22:23] sc1
    global_load_dwordx4 v[32:35], v10, s[22:23] offset:-4096 sc1
    global_load_dwordx4 v[36:39], v10, s[22:23] offset:-2048 sc1
    global_load_dwordx4 v[40:43], v10, s[22:23] offset:0 sc1
    global_load_dwordx4 v[44:47], v10, s[22:23] offset:2048 sc1
    s_memtime s[10:11]
    s_waitcnt lgkmcnt(0)
    s_load_dword s7, s[12:13], 0
    s_waitcnt lgkmcnt(0)
    s_memtime s[4:5]
    s_lshl_b32 s59, s3, 2
    v_mov_b32 v55, s59
    s_waitcnt lgkmcnt(0)
    s_sub_u32 s4, s4, s10
    v_mov_b32 v54, s4
    ds_write_b32 v55, v54 offset:3296
    s_mov_b32 s7, 0xfffffe00
    s_branch LAGbody
Lm0:
    s_cmp_eq_u32 s3, 4
    s_cbranch_scc1 Lw4
    s_cmp_eq_u32 s3, 7
    s_cbranch_scc1 Lw7
    buffer_load_dwordx4 a[0:3], v4, s[28:31], s64 offen offset:0 nt
    buffer_load_dwordx4 a[4:7], v4, s[28:31], s64 offen offset:64 nt
    buffer_load_dwordx4 a[8:11], v4, s[28:31], s64 offen offset:128 nt
    buffer_load_dwordx4 a[12:15], v4, s[28:31], s64 offen offset:192 nt
    buffer_load_dwordx4 a[16:19], v4, s[28:31], s65 offen offset:0 nt
    buffer_load_dwordx4 a[20:23], v4, s[28:31], s65 offen offset:64 nt
    buffer_load_dwordx4 a[24:27], v4, s[28:31], s65 offen offset:128 nt
    buffer_load_dwordx4 a[28:31], v4, s[28:31], s65 offen offset:192 nt
    buffer_load_dwordx4 a[32:35], v4, s[28:31], s66 offen offset:0 nt
    buffer_load_dwordx4 a[36:39], v4, s[28:31], s66 offen offset:64 nt
    buffer_load_dwordx4 a[40:43], v4, s[28:31], s66 offen offset:128 nt
    buffer_load_dwordx4 a[44:47], v4, s[28:31], s66 offen offset:192 nt
    buffer_load_dwordx4 a[48:51], v4, s[28:31], s67 offen offset:0 nt
    buffer_load_dwordx4 a[52:55], v4, s[28:31], s67 offen offset:64 nt
    buffer_load_dwordx4 a[56:59], v4, s[28:31], s67 offen offset:128 nt
    buffer_load_dwordx4 a[60:63], v4, s[28:31], s67 offen offset:192 nt
    buffer_load_dwordx4 v[96:99], v5, s[32:35], s64 offen offset:0 nt
    buffer_load_dwordx4 v[100:103], v5, s[32:35], s64 offen offset:256 nt
    buffer_load_dwordx4 v[104:107], v5, s[32:35], s64 offen offset:512 nt
    buffer_load_dwordx4 v[108:111], v5, s[32:35], s64 offen offset:768 nt
    buffer_load_dwordx4 v[112:115], v5, s[32:35], s65 offen offset:0 nt
    buffer_load_dwordx4 v[116:119], v5, s[32:35], s65 offen offset:256 nt
    buffer_load_dwordx4 v[120:123], v5, s[32:35], s65 offen offset:512 nt
    buffer_load_dwordx4 v[124:127], v5, s[32:35], s65 offen offset:768 nt
    buffer_load_dwordx4 v[128:131], v5, s[32:35], s64 offen offset:2048 nt
    buffer_load_dwordx4 v[132:135], v5, s[32:35], s64 offen offset:2304 nt
    buffer_load_dwordx4 v[136:139], v5, s[32:35], s64 offen offset:2560 nt
    buffer_load_dwordx4 v[140:143], v5, s[32:35], s64 offen offset:2816 nt
    buffer_load_dwordx4 v[144:147], v5, s[32:35], s65 offen offset:2048 nt
    buffer_load_dwordx4 v[148:151], v5, s[32:35], s65 offen offset:2304 nt
    buffer_load_dwordx4 v[152:155], v5, s[32:35], s65 offen offset:2560 nt
    buffer_load_dwordx4 v[156:159], v5, s[32:35], s65 offen offset:2816 nt
    s_branch Lm1
Lw7:
    s_mov_b32 exec_hi, 0
    ds_write_b32 v27, v6 offset:1680
    s_mov_b64 exec, -1
    s_lshl_b32 s59, s25, 16
    s_add_u32 s59, s59, 49408
    v_and_b32 v38, 0x1f0, v50
    v_add_u32 v38, s59, v38
    buffer_load_dwordx4 a[0:3], v4, s[28:31], s64 offen offset:0 nt
    buffer_load_dwordx4 a[4:7], v4, s[28:31], s64 offen offset:64 nt
    buffer_load_dwordx4 a[8:11], v4, s[28:31], s64 offen offset:128 nt
    buffer_load_dwordx4 a[12:15], v4, s[28:31], s64 offen offset:192 nt
    buffer_load_dwordx4 a[16:19], v4, s[28:31], s65 offen offset:0 nt
    buffer_load_dwordx4 a[20:23], v4, s[28:31], s65 offen offset:64 nt
    buffer_load_dwordx4 a[24:27], v4, s[28:31], s65 offen offset:128 nt
    buffer_load_dwordx4 a[28:31], v4, s[28:31], s65 offen offset:192 nt
    buffer_load_dwordx4 a[32:35], v4, s[28:31], s66 offen offset:0 nt
    buffer_load_dwordx4 a[36:39], v4, s[28:31], s66 offen offset:64 nt
    buffer_load_dwordx4 a[40:43], v4, s[28:31], s66 offen offset:128 nt
    buffer_load_dwordx4 a[44:47], v4, s[28:31], s66 offen offset:192 nt
    buffer_load_dwordx4 a[48:51], v4, s[28:31], s67 offen offset:0 nt
    buffer_load_dwordx4 a[52:55], v4, s[28:31], s67 offen offset:64 nt
    buffer_load_dwordx4 a[56:59], v4, s[28:31], s67 offen offset:128 nt
    buffer_load_dwordx4 a[60:63], v4, s[28:31], s67 offen offset:192 nt
    buffer_load_dwordx4 v[96:99], v5, s[32:35], s64 offen offset:0 nt
    buffer_load_dwordx4 v[100:103], v5, s[32:35], s64 offen offset:256 nt
    buffer_load_dwordx4 v[104:107], v5, s[32:35], s64 offen offset:512 nt
    buffer_load_dwordx4 v[108:111], v5, s[32:35], s64 offen offset:768 nt
    buffer_load_dwordx4 v[112:115], v5, s[32:35], s65 offen offset:0 nt
    buffer_load_dwordx4 v[116:119], v5, s[32:35], s65 offen offset:256 nt
    buffer_load_dwordx4 v[120:123], v5, s[32:35], s65 offen offset:512 nt
    buffer_load_dwordx4 v[124:127], v5, s[32:35], s65 offen offset:768 nt
    buffer_load_dwordx4 v[128:131], v5, s[32:35], s64 offen offset:2048 nt
    buffer_load_dwordx4 v[132:135], v5, s[32:35], s64 offen offset:2304 nt
    buffer_load_dwordx4 v[136:139], v5, s[32:35], s64 offen offset:2560 nt
    buffer_load_dwordx4 v[140:143], v5, s[32:35], s64 offen offset:2816 nt
    buffer_load_dwordx4 v[144:147], v5, s[32:35], s65 offen offset:2048 nt
    buffer_load_dwordx4 v[148:151], v5, s[32:35], s65 offen offset:2304 nt
    buffer_load_dwordx4 v[152:155], v5, s[32:35], s65 offen offset:2560 nt
    buffer_load_dwordx4 v[156:159], v5, s[32:35], s65 offen offset:2816 nt
    buffer_load_dwordx4 v[44:47], v38, s[84:87], 0 offen sc1
    s_barrier
    s_waitcnt vmcnt(9)
    v_perm_b32 v64, v100, v96, s54
    v_perm_b32 v65, v108, v104, s54
    v_perm_b32 v66, v116, v112, s54
    v_perm_b32 v67, v124, v120, s54
    v_perm_b32 v72, v100, v96, s55
    v_perm_b32 v73, v108, v104, s55
    v_perm_b32 v74, v116, v112, s55
    v_perm_b32 v75, v124, v120, s55
    v_perm_b32 v80, v101, v97, s54
    v_perm_b32 v81, v109, v105, s54
    v_perm_b32 v82, v117, v113, s54
    v_perm_b32 v83, v125, v121, s54
    v_perm_b32 v88, v101, v97, s55
    v_perm_b32 v89, v109, v105, s55
    v_perm_b32 v90, v117, v113, s55
    v_perm_b32 v91, v125, v121, s55
    v_perm_b32 v160, v102, v98, s54
    v_perm_b32 v161, v110, v106, s54
    v_perm_b32 v162, v118, v114, s54
    v_perm_b32 v163, v126, v122, s54
    v_perm_b32 v164, v102, v98, s55
    v_perm_b32 v165, v110, v106, s55
    v_perm_b32 v166, v118, v114, s55
    v_perm_b32 v167, v126, v122, s55
    v_perm_b32 v168, v103, v99, s54
    v_perm_b32 v169, v111, v107, s54
    v_perm_b32 v170, v119, v115, s54
    v_perm_b32 v171, v127, v123, s54
    v_perm_b32 v172, v103, v99, s55
    v_perm_b32 v173, v111, v107, s55
    v_perm_b32 v174, v119, v115, s55
    v_perm_b32 v175, v127, v123, s55
    v_mov_b32 v96, v160
    v_mov_b32 v97, v161
    v_mov_b32 v98, v162
    v_mov_b32 v99, v163
    v_mov_b32 v104, v164
    v_mov_b32 v105, v165
    v_mov_b32 v106, v166
    v_mov_b32 v107, v167
    v_mov_b32 v112, v168
    v_mov_b32 v113, v169
    v_mov_b32 v114, v170
    v_mov_b32 v115, v171
    v_mov_b32 v120, v172
    v_mov_b32 v121, v173
    v_mov_b32 v122, v174
    v_mov_b32 v123, v175
    s_mov_b32 s47, 200000
Lxp:
    s_waitcnt vmcnt(0)
    v_bitop3_b32 v48, v44, v45, v2 bitop3:0x7e
    v_bitop3_b32 v49, v46, v47, v2 bitop3:0x7e
    v_or_b32 v48, v48, v49
    v_and_b32 v48, 0xff, v48
    v_cmp_ne_u32 vcc, 0, v48
    s_cbranch_vccz Lxk
    buffer_load_dwordx4 v[44:47], v38, s[84:87], 0 offen sc1
    s_sub_u32 s47, s47, 1
    s_nop 0
    s_cbranch_scc0 Lxp
    s_waitcnt vmcnt(0)
Lxk:
    v_lshrrev_b32 v44, 8, v44
    v_cmp_ne_u32 vcc, s48, v44
    s_nop 0
    s_cmp_eq_u64 vcc, 0
    s_cselect_b32 s59, 1, 0
    v_mov_b32 v44, s59
    v_mov_b32 v45, 132
    ds_write_b32 v45, v44
    s_branch Lm2
Lw4:
    v_readfirstlane_b32 s59, v23
    s_nop 0
    s_and_b32 s59, s59, 0xfffffe00
    v_add_u32 v32, s59, v27
    v_add_u32 v33, 0x4000, v32
    v_add_u32 v34, 0x8000, v32
    s_lshl_b32 s59, s25, 16
    s_lshl_b32 s60, s26, 4
    s_add_u32 s60, s60, s59
    s_add_u32 s60, s60, 49408
    s_lshl_b32 s61, s42, 10
    s_add_u32 s59, s59, s61
    s_lshl_b32 s61, s41, 5
    s_add_u32 s59, s59, s61
    s_add_u32 s59, s59, 49152
    v_add_u32 v35, s59, v50
    v_mov_b32 v36, s60
    s_mov_b64 vcc, 3
    v_cndmask_b32 v35, v36, v35, vcc
    v_add_u32 v37, 524288, v59
    v_add_u32 v38, 8192, v59
    v_add_u32 v39, 8192, v37
    v_bfe_u32 v46, v1, 1, 2
    v_lshl_add_u32 v46, v46, 7, s10
    v_and_b32 v47, 1, v1
    v_lshl_add_u32 v46, v47, 13, v46
    v_mov_b32 v76, 0
    v_mov_b32 v77, 0
    v_mov_b32 v78, 0
    v_mov_b32 v79, 0
    s_mov_b32 s47, 800000
Lw4p:
    ds_read_b128 v[72:75], v50 offset:7424
    ds_read_b128 v[64:67], v50 offset:5376
    ds_read_b128 v[68:71], v50 offset:6400
    s_waitcnt lgkmcnt(0)
    v_bitop3_b32 v40, v74, v75, v2 bitop3:0x7e
    v_and_b32 v40, 0xff, v40
    v_cmp_ne_u32 vcc, 0, v40
    s_cbranch_vccz Lw4k
    s_sleep 1
    s_sub_u32 s47, s47, 1
    s_nop 0
    s_cbranch_scc0 Lw4p
Lw4k:
    global_store_dword v32, v64, s[22:23] offset:0 sc1
    global_store_dword v33, v65, s[22:23] offset:0 sc1
    global_store_dword v34, v66, s[22:23] offset:0 sc1
    global_store_dword v32, v68, s[22:23] offset:256 sc1
    global_store_dword v33, v69, s[22:23] offset:256 sc1
    global_store_dword v34, v70, s[22:23] offset:256 sc1
    global_store_dwordx4 v35, v[72:75], s[22:23] sc1
    global_store_dword v46, v76, s[22:23] sc1
    s_nop 0
    buffer_load_dwordx4 a[0:3], v4, s[28:31], s64 offen offset:0 nt
    buffer_load_dwordx4 a[4:7], v4, s[28:31], s64 offen offset:64 nt
    buffer_load_dwordx4 a[8:11], v4, s[28:31], s64 offen offset:128 nt
    buffer_load_dwordx4 a[12:15], v4, s[28:31], s64 offen offset:192 nt
    buffer_load_dwordx4 a[16:19], v4, s[28:31], s65 offen offset:0 nt
    buffer_load_dwordx4 a[20:23], v4, s[28:31], s65 offen offset:64 nt
    buffer_load_dwordx4 a[24:27], v4, s[28:31], s65 offen offset:128 nt
    buffer_load_dwordx4 a[28:31], v4, s[28:31], s65 offen offset:192 nt
    buffer_load_dwordx4 a[32:35], v4, s[28:31], s66 offen offset:0 nt
    buffer_load_dwordx4 a[36:39], v4, s[28:31], s66 offen offset:64 nt
    buffer_load_dwordx4 a[40:43], v4, s[28:31], s66 offen offset:128 nt
    buffer_load_dwordx4 a[44:47], v4, s[28:31], s66 offen offset:192 nt
    buffer_load_dwordx4 a[48:51], v4, s[28:31], s67 offen offset:0 nt
    buffer_load_dwordx4 a[52:55], v4, s[28:31], s67 offen offset:64 nt
    buffer_load_dwordx4 a[56:59], v4, s[28:31], s67 offen offset:128 nt
    buffer_load_dwordx4 a[60:63], v4, s[28:31], s67 offen offset:192 nt
    buffer_load_dwordx4 v[96:99], v5, s[32:35], s64 offen offset:0 nt
    buffer_load_dwordx4 v[100:103], v5, s[32:35], s64 offen offset:256 nt
    buffer_load_dwordx4 v[104:107], v5, s[32:35], s64 offen offset:512 nt
    buffer_load_dwordx4 v[108:111], v5, s[32:35], s64 offen offset:768 nt
    buffer_load_dwordx4 v[112:115], v5, s[32:35], s65 offen offset:0 nt
    buffer_load_dwordx4 v[116:119], v5, s[32:35], s65 offen offset:256 nt
    buffer_load_dwordx4 v[120:123], v5, s[32:35], s65 offen offset:512 nt
    buffer_load_dwordx4 v[124:127], v5, s[32:35], s65 offen offset:768 nt
    buffer_load_dwordx4 v[128:131], v5, s[32:35], s64 offen offset:2048 nt
    buffer_load_dwordx4 v[132:135], v5, s[32:35], s64 offen offset:2304 nt
    buffer_load_dwordx4 v[136:139], v5, s[32:35], s64 offen offset:2560 nt
    buffer_load_dwordx4 v[140:143], v5, s[32:35], s64 offen offset:2816 nt
    buffer_load_dwordx4 v[144:147], v5, s[32:35], s65 offen offset:2048 nt
    buffer_load_dwordx4 v[148:151], v5, s[32:35], s65 offen offset:2304 nt
    buffer_load_dwordx4 v[152:155], v5, s[32:35], s65 offen offset:2560 nt
    buffer_load_dwordx4 v[156:159], v5, s[32:35], s65 offen offset:2816 nt
Lm1:
    s_barrier
    s_waitcnt vmcnt(8)
    v_perm_b32 v64, v100, v96, s54
    v_perm_b32 v65, v108, v104, s54
    v_perm_b32 v66, v116, v112, s54
    v_perm_b32 v67, v124, v120, s54
    v_perm_b32 v72, v100, v96, s55
    v_perm_b32 v73, v108, v104, s55
    v_perm_b32 v74, v116, v112, s55
    v_perm_b32 v75, v124, v120, s55
    v_perm_b32 v80, v101, v97, s54
    v_perm_b32 v81, v109, v105, s54
    v_perm_b32 v82, v117, v113, s54
    v_perm_b32 v83, v125, v121, s54
    v_perm_b32 v88, v101, v97, s55
    v_perm_b32 v89, v109, v105, s55
    v_perm_b32 v90, v117, v113, s55
    v_perm_b32 v91, v125, v121, s55
    v_perm_b32 v160, v102, v98, s54
    v_perm_b32 v161, v110, v106, s54
    v_perm_b32 v162, v118, v114, s54
    v_perm_b32 v163, v126, v122, s54
    v_perm_b32 v164, v102, v98, s55
    v_perm_b32 v165, v110, v106, s55
    v_perm_b32 v166, v118, v114, s55
    v_perm_b32 v167, v126, v122, s55
    v_perm_b32 v168, v103, v99, s54
    v_perm_b32 v169, v111, v107, s54
    v_perm_b32 v170, v119, v115, s54
    v_perm_b32 v171, v127, v123, s54
    v_perm_b32 v172, v103, v99, s55
    v_perm_b32 v173, v111, v107, s55
    v_perm_b32 v174, v119, v115, s55
    v_perm_b32 v175, v127, v123, s55
    v_mov_b32 v96, v160
    v_mov_b32 v97, v161
    v_mov_b32 v98, v162
    v_mov_b32 v99, v163
    v_mov_b32 v104, v164
    v_mov_b32 v105, v165
    v_mov_b32 v106, v166
    v_mov_b32 v107, v167
    v_mov_b32 v112, v168
    v_mov_b32 v113, v169
    v_mov_b32 v114, v170
    v_mov_b32 v115, v171
    v_mov_b32 v120, v172
    v_mov_b32 v121, v173
    v_mov_b32 v122, v174
    v_mov_b32 v123, v175
    s_waitcnt vmcnt(0)
Lm2:
    s_sub_u32 s59, s3, 5
    s_cmp_lt_u32 s59, 2
    s_cbranch_scc0 Lnocpw
    s_mul_i32 s59, s59, 524288
    v_add_u32 v44, s59, v59
    v_add_u32 v45, 8192, v44
    v_mov_b32 v40, 0
    v_mov_b32 v41, 0
    v_mov_b32 v42, 0
    v_mov_b32 v43, 0
    global_store_dwordx4 v44, v[40:43], s[22:23] sc1
    global_store_dwordx4 v45, v[40:43], s[22:23] sc1
Lnocpw:
    s_mov_b32 s36, s16
    s_mov_b32 s37, s17
    s_mov_b32 s38, 1835008
    s_and_b32 s59, s3, 3
    s_lshl_b32 s59, s59, 11
    s_add_u32 m0, s59, 38144
    s_add_u32 s60, s14, 27648
    buffer_load_dwordx4 v57, s[36:39], s14 offen nt lds
    buffer_load_dwordx4 v57, s[36:39], s60 offen offset:1024 nt lds
    s_mov_b32 s36, s18
    s_mov_b32 s37, s19
    s_add_u32 m0, s59, 46336
    s_add_u32 s60, s15, 7168
    buffer_load_dwordx4 v58, s[36:39], s15 offen nt lds
    buffer_load_dwordx4 v58, s[36:39], s60 offen offset:1024 nt lds
    s_mov_b32 vcc_lo, 0x11111111
    s_mov_b32 vcc_hi, 0x11111111
    v_mov_b32 v58, s44
    v_cndmask_b32 v57, -1, v58, vcc
    v_cndmask_b32 v58, 0, v2, vcc
    v_perm_b32 v68, v132, v128, s54
    v_perm_b32 v69, v140, v136, s54
    v_perm_b32 v70, v148, v144, s54
    v_perm_b32 v71, v156, v152, s54
    v_perm_b32 v76, v132, v128, s55
    v_perm_b32 v77, v140, v136, s55
    v_perm_b32 v78, v148, v144, s55
    v_perm_b32 v79, v156, v152, s55
    v_perm_b32 v84, v133, v129, s54
    v_perm_b32 v85, v141, v137, s54
    v_perm_b32 v86, v149, v145, s54
    v_perm_b32 v87, v157, v153, s54
    v_perm_b32 v92, v133, v129, s55
    v_perm_b32 v93, v141, v137, s55
    v_perm_b32 v94, v149, v145, s55
    v_perm_b32 v95, v157, v153, s55
    v_perm_b32 v100, v134, v130, s54
    v_perm_b32 v101, v142, v138, s54
    v_perm_b32 v102, v150, v146, s54
    v_perm_b32 v103, v158, v154, s54
    v_perm_b32 v108, v134, v130, s55
    v_perm_b32 v109, v142, v138, s55
    v_perm_b32 v110, v150, v146, s55
    v_perm_b32 v111, v158, v154, s55
    v_perm_b32 v116, v135, v131, s54
    v_perm_b32 v117, v143, v139, s54
    v_perm_b32 v118, v151, v147, s54
    v_perm_b32 v119, v159, v155, s54
    v_perm_b32 v124, v135, v131, s55
    v_perm_b32 v125, v143, v139, s55
    v_perm_b32 v126, v151, v147, s55
    v_perm_b32 v127, v159, v155, s55
    v_mov_b32 v152, 0
    v_mov_b32 v153, 0
    v_mov_b32 v154, 0
    v_mov_b32 v155, 0
    v_mov_b32 v156, 0
    v_mov_b32 v157, 0
    v_mov_b32 v158, 0
    v_mov_b32 v159, 0
LB1m:
    s_setprio 2
    v_mov_b32 v128, 0
    v_mov_b32 v129, 0
    v_mov_b32 v130, 0
    v_mov_b32 v131, 0
    v_mov_b32 v132, 0
    v_mov_b32 v133, 0
    v_mov_b32 v134, 0
    v_mov_b32 v135, 0
    v_mov_b32 v136, 0
    v_mov_b32 v137, 0
    v_mov_b32 v138, 0
    v_mov_b32 v139, 0
    v_mov_b32 v140, 0
    v_mov_b32 v141, 0
    v_mov_b32 v142, 0
    v_mov_b32 v143, 0
    s_cmp_eq_u32 s3, 6
    s_cbranch_scc0 LB1
    s_mov_b32 exec_hi, 1
    ds_write_b32 v27, v128 offset:0
    s_mov_b64 exec, -1
    s_branch LB1
LAG:
    s_mov_b32 s47, 200000
Lpoll1:
    global_load_dwordx4 v[48:51], v11, s[22:23] sc1
    global_load_dwordx4 v[32:35], v10, s[22:23] offset:-4096 sc1
    global_load_dwordx4 v[36:39], v10, s[22:23] offset:-2048 sc1
    global_load_dwordx4 v[40:43], v10, s[22:23] offset:0 sc1
    global_load_dwordx4 v[44:47], v10, s[22:23] offset:2048 sc1
LAGbody:
    s_waitcnt vmcnt(4)
    v_add_f32_dpp v54, v48, v48 row_ror:1 row_mask:0xf bank_mask:0xf
    v_add_f32_dpp v55, v49, v49 row_ror:1 row_mask:0xf bank_mask:0xf
    v_bitop3_b32 v164, v50, v51, v60 bitop3:0x7e
    v_add_f32_dpp v54, v54, v54 row_ror:2 row_mask:0xf bank_mask:0xf
    v_add_f32_dpp v55, v55, v55 row_ror:2 row_mask:0xf bank_mask:0xf
    s_nop 0
    v_add_f32_dpp v54, v54, v54 row_ror:4 row_mask:0xf bank_mask:0xf
    v_add_f32_dpp v55, v55, v55 row_ror:4 row_mask:0xf bank_mask:0xf
    v_mul_f32 v52, 0x3b000000, v55
    v_fmaak_f32 v54, v148, v54, 0x3727c5ac
    v_fma_f32 v54, -v52, v52, v54
    v_max_f32 v54, 0x3727c5ac, v54
    v_rsq_f32 v53, v54
    s_nop 0
    v_mul_f32 v53, 0x3e0293ee, v53
    s_waitcnt vmcnt(2)
    v_xor_b32 v32, s43, v32
    v_xor_b32 v36, s43, v36
    v_or_b32 v160, v32, v36
    v_pk_add_f32 v[32:33], v[32:33], v[36:37]
    v_pk_add_f32 v[34:35], v[34:35], v[38:39]
    s_waitcnt vmcnt(0)
    v_xor_b32 v40, s43, v40
    v_xor_b32 v44, s43, v44
    v_or3_b32 v160, v160, v40, v44
    v_and_or_b32 v160, v160, s6, v164
    v_cmp_ne_u32 vcc, 0, v160
    s_cbranch_vccnz Lretry2
Lok3:
    v_pk_add_f32 v[40:41], v[40:41], v[44:45]
    v_pk_add_f32 v[42:43], v[42:43], v[46:47]
    v_pk_add_f32 v[32:33], v[32:33], v[40:41]
    v_pk_add_f32 v[34:35], v[34:35], v[42:43]
    s_nop 1
    v_permlane32_swap_b32 v32, v34
    v_permlane32_swap_b32 v33, v35
    v_pk_add_f32 v[32:33], v[32:33], v[34:35]
    v_fma_f32 v32, -v52, v4, v32
    v_fma_f32 v33, -v52, v5, v33
    v_mul_f32 v32, v32, v53
    v_mul_f32 v33, v33, v53
    v_cvt_pk_bf16_f32 v32, v32, v33
    ds_write_b32 v24, v32
    s_cmp_eq_u32 s46, 0
    s_cbranch_scc0 Ll04
    ds_read_u16_d16_hi v3, v29
    global_load_dwordx4 v[144:147], v59, s[22:23] sc1
    s_lshl_b32 s59, s3, 12
    s_add_u32 m0, s59, 54528
    s_nop 0
    buffer_load_dwordx4 v56, s[36:39], s64 offen offset:0 nt lds
    buffer_load_dwordx4 v56, s[36:39], s65 offen offset:1024 nt lds
    buffer_load_dwordx4 v56, s[36:39], s66 offen offset:2048 nt lds
    buffer_load_dwordx4 v56, s[36:39], s67 offen offset:3072 nt lds
Ll04:
LB1:
    s_waitcnt lgkmcnt(0)
    s_barrier
    ds_read_b128 v[160:163], v25 offset:0
    ds_read_b128 v[164:167], v25 offset:64
    ds_read_b128 v[168:171], v25 offset:128
    ds_read_b128 v[172:175], v25 offset:192
    s_mov_b32 vcc_lo, 0xf0f0f0f0
    s_mov_b32 vcc_hi, 0xf0f0f0f0
    s_waitcnt lgkmcnt(3)
    v_mfma_f32_16x16x32_bf16 v[176:179], a[0:3], v[160:163], 0
    s_waitcnt lgkmcnt(2)
    v_mfma_f32_16x16x32_bf16 v[176:179], a[4:7], v[164:167], v[176:179]
    s_waitcnt lgkmcnt(1)
    v_mfma_f32_16x16x32_bf16 v[176:179], a[8:11], v[168:171], v[176:179]
    s_waitcnt lgkmcnt(0)
    v_mfma_f32_16x16x32_bf16 v[176:179], a[12:15], v[172:175], v[176:179]
    v_mfma_f32_16x16x32_bf16 v[180:183], a[16:19], v[160:163], 0
    v_mfma_f32_16x16x32_bf16 v[180:183], a[20:23], v[164:167], v[180:183]
    v_mfma_f32_16x16x32_bf16 v[180:183], a[24:27], v[168:171], v[180:183]
    v_mfma_f32_16x16x32_bf16 v[180:183], a[28:31], v[172:175], v[180:183]
    v_mfma_f32_16x16x32_bf16 v[184:187], a[32:35], v[160:163], 0
    v_cndmask_b32 v176, v176, v178, vcc
    v_mfma_f32_16x16x32_bf16 v[184:187], a[36:39], v[164:167], v[184:187]
    v_cndmask_b32 v177, v177, v179, vcc
    v_mfma_f32_16x16x32_bf16 v[184:187], a[40:43], v[168:171], v[184:187]
    v_exp_f32 v176, v176
    v_mfma_f32_16x16x32_bf16 v[184:187], a[44:47], v[172:175], v[184:187]
    v_exp_f32 v177, v177
    v_mfma_f32_16x16x32_bf16 v[188:191], a[48:51], v[160:163], 0
    v_cndmask_b32 v180, v180, v182, vcc
    v_mfma_f32_16x16x32_bf16 v[188:191], a[52:55], v[164:167], v[188:191]
    v_cndmask_b32 v181, v181, v183, vcc
    v_mfma_f32_16x16x32_bf16 v[188:191], a[56:59], v[168:171], v[188:191]
    v_exp_f32 v180, v180
    v_mfma_f32_16x16x32_bf16 v[188:191], a[60:63], v[172:175], v[188:191]
    v_exp_f32 v181, v181
    v_cndmask_b32 v184, v184, v186, vcc
    v_cndmask_b32 v185, v185, v187, vcc
    v_exp_f32 v184, v184
    v_exp_f32 v185, v185
    v_add_f32 v36, v176, v177
    v_add_f32 v37, v180, v181
    s_nop 0
    v_cndmask_b32 v188, v188, v190, vcc
    v_cndmask_b32 v189, v189, v191, vcc
    v_exp_f32 v188, v188
    v_exp_f32 v189, v189
    s_setprio 1
    s_mov_b64 exec, s[8:9]
    v_cvt_pk_bf16_f32 v152, v176, v177
    v_cvt_pk_bf16_f32 v153, v180, v181
    v_cvt_pk_bf16_f32 v154, v184, v185
    v_cvt_pk_bf16_f32 v155, v188, v189
    s_not_b64 exec, exec
    v_cvt_pk_bf16_f32 v156, v176, v177
    v_cvt_pk_bf16_f32 v157, v180, v181
    v_cvt_pk_bf16_f32 v158, v184, v185
    v_cvt_pk_bf16_f32 v159, v188, v189
    s_mov_b64 exec, -1
    v_smfmac_f32_16x16x64_bf16 v[128:131], v[152:155], v[64:71], v7
    v_add_f32 v38, v184, v185
    v_smfmac_f32_16x16x64_bf16 v[132:135], v[152:155], v[72:79], v7
    v_add_f32 v36, v36, v37
    v_smfmac_f32_16x16x64_bf16 v[136:139], v[152:155], v[96:103], v7
    v_add_f32 v39, v188, v189
    v_smfmac_f32_16x16x64_bf16 v[140:143], v[152:155], v[104:111], v7
    v_add_f32 v36, v36, v38
    v_smfmac_f32_16x16x64_bf16 v[128:131], v[156:159], v[80:87], v7
    v_add_f32 v36, v36, v39
    v_smfmac_f32_16x16x64_bf16 v[132:135], v[156:159], v[88:95], v7
    ds_write_b32 v8, v36 offset:3328
    v_smfmac_f32_16x16x64_bf16 v[136:139], v[156:159], v[112:119], v7
    v_med3_f32 v37, v36, s40, v61
    v_smfmac_f32_16x16x64_bf16 v[140:143], v[156:159], v[120:127], v7
    v_cmp_neq_f32 vcc, v36, v37
    s_cmp_lt_u32 s3, 4
    s_cbranch_vccnz Lfb
Lfbback:
    v_permlane16_swap_b32 v128, v132
    v_permlane16_swap_b32 v129, v133
    v_permlane16_swap_b32 v130, v134
    v_permlane16_swap_b32 v131, v135
    v_pk_add_f32 v[128:129], v[128:129], v[132:133]
    v_pk_add_f32 v[130:131], v[130:131], v[134:135]
    ds_write_b128 v26, v[128:131] offset:0
    v_permlane16_swap_b32 v136, v140
    v_permlane16_swap_b32 v137, v141
    v_permlane16_swap_b32 v138, v142
    v_permlane16_swap_b32 v139, v143
    v_pk_add_f32 v[136:137], v[136:137], v[140:141]
    v_pk_add_f32 v[138:139], v[138:139], v[142:143]
    ds_write_b128 v26, v[136:139] offset:1024
    v_mov_b32 v40, 0
    s_cbranch_scc1 LG2
    s_waitcnt lgkmcnt(0)
    s_barrier
    ds_read_b64 v[40:41], v40 offset:128
    ds_read_b128 v[128:131], v9 offset:0
    ds_read_b128 v[132:135], v9 offset:2048
    ds_read_b128 v[136:139], v9 offset:4096
    ds_read_b128 v[140:143], v9 offset:6144
    s_waitcnt lgkmcnt(4)
    v_readfirstlane_b32 s45, v41
    v_cmp_ne_u32 vcc, 0, v40
    s_waitcnt lgkmcnt(2)
    v_pk_add_f32 v[32:33], v[128:129], v[132:133]
    v_pk_add_f32 v[34:35], v[130:131], v[134:135]
    s_cbranch_vccnz Lsc
    s_waitcnt lgkmcnt(1)
    v_pk_add_f32 v[32:33], v[32:33], v[136:137]
    v_pk_add_f32 v[34:35], v[34:35], v[138:139]
    s_waitcnt lgkmcnt(0)
    v_pk_add_f32 v[32:33], v[32:33], v[140:141]
    v_pk_add_f32 v[34:35], v[34:35], v[142:143]
Lscback:
    s_cmp_eq_u32 s45, 0
    s_nop 0
    v_permlane32_swap_b32 v32, v34
    v_permlane32_swap_b32 v33, v35
    v_pk_add_f32 v[32:33], v[32:33], v[34:35]
    v_and_or_b32 v32, v32, s44, v2
    s_cbranch_scc1 Lslow5
    global_store_dwordx2 v12, v[32:33], s[22:23]
Lback6:
    s_lshl_b32 s59, s3, 5
    s_add_u32 s59, s59, 54400
    v_add_u32 v47, s59, v31
    s_barrier
    ds_read_b64_tr_b16 v[176:177], v47 offset:0
    ds_read_b64_tr_b16 v[178:179], v47 offset:512
    ds_read_b64_tr_b16 v[180:181], v47 offset:4096
    ds_read_b64_tr_b16 v[182:183], v47 offset:4608
    ds_read_b64_tr_b16 v[184:185], v47 offset:8192
    ds_read_b64_tr_b16 v[186:187], v47 offset:8704
    ds_read_b64_tr_b16 v[188:189], v47 offset:12288
    ds_read_b64_tr_b16 v[190:191], v47 offset:12800
    s_waitcnt vmcnt(0) lgkmcnt(0)
    s_barrier
    ds_read_b128 v[32:35], v0 offset:0
    ds_read_b128 v[36:39], v0 offset:64
    ds_read_b128 v[40:43], v0 offset:128
    ds_read_b128 v[44:47], v0 offset:192
    s_waitcnt lgkmcnt(3)
    v_mfma_f32_16x16x32_bf16 v[48:51], v[32:35], v[176:179], 0
    s_waitcnt lgkmcnt(2)
    v_mfma_f32_16x16x32_bf16 v[48:51], v[36:39], v[180:183], v[48:51]
    s_waitcnt lgkmcnt(1)
    v_mfma_f32_16x16x32_bf16 v[48:51], v[40:43], v[184:187], v[48:51]
    s_waitcnt lgkmcnt(0)
    v_mfma_f32_16x16x32_bf16 v[48:51], v[44:47], v[188:191], v[48:51]
    s_nop 7
    v_and_or_b32 v48, v48, v57, v58
    global_store_dword v22, v48, s[50:51] sc1
    s_lshl_b32 s59, s3, 5
    s_add_u32 s59, s59, 46208
    v_add_u32 v47, s59, v31
    s_cmp_eq_u32 s46, 0
    s_cbranch_scc0 Ll07
    s_waitcnt vmcnt(0)
Ll07:
    s_barrier
    s_cmp_eq_u32 s46, 0
    s_cbranch_scc0 Ll08
    v_mov_b32 v32, 0
    ds_read_b32 v32, v32 offset:3312
    s_waitcnt lgkmcnt(0)
    v_xor_b32 v32, 0x2000, v32
    v_xor_b32 v22, v32, v22
Ll08:
    s_cmp_eq_u32 s3, 4
    s_barrier
    s_cbranch_scc0 Lm5
    ds_read_b128 v[32:35], v30
    ds_read_b128 v[36:39], v30 offset:64
    s_cmp_eq_u32 s45, 0
    s_waitcnt lgkmcnt(1)
    v_mfma_f32_16x16x32_bf16 v[40:43], v[32:35], v[32:35], 0
    s_waitcnt lgkmcnt(0)
    v_mfma_f32_16x16x32_bf16 v[40:43], v[36:39], v[36:39], v[40:43]
    s_mov_b64 vcc, 0x01100101
    s_mov_b64 exec, 0x01160107
    s_nop 5
    v_cndmask_b32 v144, v60, v40, vcc
    s_cbranch_scc1 Lslow9
    global_store_dword v19, v144, s[22:23]
Lback10:
    s_mov_b64 exec, -1
Lm5:
    ds_read_b64_tr_b16 v[160:161], v47 offset:0
    ds_read_b64_tr_b16 v[162:163], v47 offset:512
    ds_read_b64_tr_b16 v[164:165], v47 offset:4096
    ds_read_b64_tr_b16 v[166:167], v47 offset:4608
    s_sub_u32 s59, s3, 7
    s_or_b32 s59, s59, s2
    s_or_b32 s59, s59, s46
    s_cbranch_scc1 Lm6
    s_cmp_eq_u32 s43, 0xff
    s_cselect_b32 s59, 0, s43
    s_add_u32 s59, s59, 1
    v_mov_b32 v33, 0xf000
    v_mov_b32 v34, s59
    s_mov_b64 exec, 1
    global_store_dword v33, v34, s[22:23] sc1
    s_mov_b64 exec, -1
Lm6:
    v_and_b32 v47, 0xffffff80, v31
    s_lshl_b32 s59, s3, 5
    v_add3_u32 v47, v47, v31, s59
    s_or_b32 s59, s25, s42
    s_mul_i32 s59, s59, s46
    s_cmp_lg_u32 s59, 0
    s_waitcnt lgkmcnt(0)
    s_barrier
    ds_read_b128 v[32:35], v53 offset:1872
    ds_read_b128 v[36:39], v53 offset:1936
    s_waitcnt lgkmcnt(1)
    v_mfma_f32_16x16x32_bf16 v[40:43], v[32:35], v[160:163], 0
    s_waitcnt lgkmcnt(0)
    v_mfma_f32_16x16x32_bf16 v[40:43], v[36:39], v[164:167], v[40:43]
    s_nop 7
    v_and_or_b32 v40, v40, v57, v58
    global_store_dword v22, v40, s[52:53] sc1
    s_cbranch_scc1 Lfin
    ds_read_b64_tr_b16 v[168:169], v47 offset:21760
    ds_read_b64_tr_b16 v[170:171], v47 offset:22784
    ds_read_b64_tr_b16 v[172:173], v47 offset:29952
    ds_read_b64_tr_b16 v[174:175], v47 offset:30976
    s_barrier
    s_cmp_eq_u32 s46, 0
    s_cbranch_scc0 Lfin
    s_cmp_eq_u32 s43, 0xff
    s_cselect_b32 s16, 0, s43
    s_add_u32 s16, s16, 1
    s_mul_i32 s17, s16, 0x01010101
    v_mov_b32 v151, s16
    v_bfi_b32 v151, v57, 0, v151
    s_cmp_eq_u32 s45, 0
    s_waitcnt lgkmcnt(0)
    s_barrier
    ds_read_b128 v[32:35], v30
    ds_read_b128 v[36:39], v30 offset:64
    s_waitcnt lgkmcnt(1)
    v_mfma_f32_16x16x32_bf16 v[40:43], v[32:35], v[168:171], 0
    s_waitcnt lgkmcnt(0)
    v_mfma_f32_16x16x32_bf16 v[40:43], v[36:39], v[172:175], v[40:43]
    s_mov_b32 exec_hi, 0
    s_nop 6
    v_and_or_b32 v40, v40, v57, v151
    s_cbranch_scc1 Lslow11
    global_store_dword v23, v40, s[22:23]
Lback12:
    s_mov_b64 exec, -1
    s_mov_b32 s43, s16
    v_mov_b32 v2, s16
    v_mov_b32 v60, s17
    v_mov_b32 v58, v151
    s_add_u32 s50, s50, 524288
    s_addc_u32 s51, s51, 0
    s_add_u32 s52, s52, 524288
    s_addc_u32 s53, s53, 0
    s_mov_b32 s46, 1
    s_branch LB1m
LG2:
    s_setprio 3
    ds_read_b128 v[44:47], v40 offset:3296
    v_mov_b32 v48, v2
    s_cmp_eq_u32 s3, 0
    s_waitcnt lgkmcnt(0)
    v_add_u32 v44, v44, v46
    v_add_u32 v45, v45, v47
    v_or_b32 v46, 0x100, v2
    v_cmp_lt_u32 vcc, v45, v44
    s_nop 1
    v_cndmask_b32 v47, v2, v46, vcc
    s_barrier
    ds_read_b64 v[40:41], v40 offset:128
    s_cbranch_scc0 Lnl
    ds_read2st64_b32 v[32:33], v27 offset0:13 offset1:14
    ds_read2st64_b32 v[34:35], v27 offset0:15 offset1:16
    ds_read2st64_b32 v[36:37], v27 offset0:17 offset1:18
    ds_read2st64_b32 v[38:39], v27 offset0:19 offset1:20
    s_waitcnt lgkmcnt(4)
    v_readfirstlane_b32 s45, v41
    v_cmp_ne_u32 vcc, 0, v40
    s_waitcnt lgkmcnt(0)
    s_cbranch_vccnz Lsl
    v_pk_add_f32 v[32:33], v[32:33], v[34:35]
    v_pk_add_f32 v[36:37], v[36:37], v[38:39]
    v_pk_add_f32 v[32:33], v[32:33], v[36:37]
    v_add_f32 v49, v32, v33
Lslback:
    s_nop 1
    v_add_f32_dpp v49, v49, v49 row_ror:4 row_mask:0xf bank_mask:0xf
    v_mov_b32 v51, v49
    s_nop 1
    v_permlane16_swap_b32 v49, v51
    v_add_f32 v49, v49, v51
    v_mov_b32 v51, v49
    s_nop 1
    v_permlane32_swap_b32 v49, v51
    v_add_f32 v49, v49, v51
    s_cmp_eq_u32 s45, 0
    v_and_or_b32 v49, v49, s7, v47
    s_mov_b64 exec, 0xf
    s_cbranch_scc1 Lslow13
    global_store_dwordx2 v13, v[48:49], s[22:23]
Lback14:
    s_mov_b64 exec, -1
    s_branch Lnl2
Lnl:
    s_waitcnt lgkmcnt(0)
    v_readfirstlane_b32 s45, v41
Lnl2:
    s_waitcnt vmcnt(1)
    s_cmp_eq_u32 s3, 0
    s_cbranch_scc1 Lnl3
    s_waitcnt vmcnt(0)
Lnl3:
    s_barrier
    s_sleep 4
    s_mov_b32 s47, 200000
Lpoll15:
    global_load_dwordx2 v[48:49], v15, s[22:23] sc1
    global_load_dwordx4 v[32:35], v14, s[22:23] offset:-4096 sc1
    global_load_dwordx4 v[36:39], v14, s[22:23] offset:-2048 sc1
    global_load_dwordx4 v[40:43], v14, s[22:23] offset:0 sc1
    global_load_dwordx4 v[44:47], v14, s[22:23] offset:2048 sc1
Lbody18:
    s_waitcnt vmcnt(4)
    v_and_b32 v52, s7, v49
    v_cmp_ne_u32 s[56:57], v48, v2
    v_and_b32 v53, 0x100, v49
    v_add_f32_dpp v52, v52, v52 row_ror:4 row_mask:0xf bank_mask:0xf
    v_bitop3_b32 v184, v48, v49, v2 bitop3:0x7e
    v_cmp_ne_u32 s[10:11], 0, v53
    v_add_f32_dpp v52, v52, v52 row_ror:8 row_mask:0xf bank_mask:0xf
    v_mov_b32 v51, v52
    s_nop 1
    v_permlane16_swap_b32 v52, v51
    v_add_f32 v52, v52, v51
    v_mov_b32 v51, v52
    s_nop 1
    v_permlane32_swap_b32 v52, v51
    v_add_f32 v52, v52, v51
    v_rcp_f32 v52, v52
    s_nop 1
    v_mov_b32_dpp v50, v52 quad_perm:[0,0,0,0] row_mask:0x1 bank_mask:0xf
    v_mov_b32_dpp v50, v52 quad_perm:[1,1,1,1] row_mask:0x2 bank_mask:0xf
    v_mov_b32_dpp v50, v52 quad_perm:[2,2,2,2] row_mask:0x4 bank_mask:0xf
    v_mov_b32_dpp v50, v52 quad_perm:[3,3,3,3] row_mask:0x8 bank_mask:0xf
    s_waitcnt vmcnt(2)
    v_xor_b32 v32, s43, v32
    v_xor_b32 v34, s43, v34
    v_xor_b32 v36, s43, v36
    v_xor_b32 v38, s43, v38
    v_or3_b32 v176, v32, v34, v184
    v_or3_b32 v176, v176, v36, v38
    v_pk_add_f32 v[164:165], v[32:33], v[36:37]
    v_pk_add_f32 v[166:167], v[34:35], v[38:39]
    s_waitcnt vmcnt(0)
    v_xor_b32 v40, s43, v40
    v_xor_b32 v42, s43, v42
    v_xor_b32 v44, s43, v44
    v_xor_b32 v46, s43, v46
    v_or3_b32 v176, v176, v40, v42
    v_or3_b32 v176, v176, v44, v46
    v_cmp_ne_u32_sdwa vcc, v176, 0 src0_sel:BYTE_0 src1_sel:DWORD
    s_cbranch_vccnz Lretry16
Lok17:
    v_pk_add_f32 v[180:181], v[40:41], v[44:45]
    v_pk_add_f32 v[182:183], v[42:43], v[46:47]
    v_pk_add_f32 v[164:165], v[164:165], v[180:181]
    v_pk_add_f32 v[166:167], v[166:167], v[182:183]
    s_nop 1
    v_permlane32_swap_b32 v164, v166
    v_permlane32_swap_b32 v165, v167
    v_add_f32 v164, v164, v166
    v_add_f32 v165, v165, v167
    s_cmp_lg_u64 s[56:57], 0
    s_nop 0
    v_permlane16_swap_b32 v164, v165
    v_add_f32 v164, v164, v165
    s_cbranch_scc1 Loslow
    v_mul_f32 v32, v164, v50
Loback:
    v_cvt_pk_bf16_f32 v32, v32, v32
    ds_write_b16 v16, v32
    s_waitcnt lgkmcnt(0)
    s_barrier
    s_lshl_b32 s59, s3, 5
    s_add_u32 s59, s59, 38144
    v_add_u32 v54, s59, v31
    s_cmp_eq_u32 s46, 0
    s_cbranch_scc0 Ll019
    s_bcnt1_i32_b64 s59, s[10:11]
    s_cmp_gt_u32 s59, 32
    s_cselect_b32 s59, 8192, 0
    v_add_u32 v17, s59, v17
    v_mov_b32 v32, s59
    v_mov_b32 v33, 0
    ds_write_b32 v33, v32 offset:3312
    s_waitcnt lgkmcnt(0)
Ll019:
    s_cmp_eq_u32 s46, 0
    s_cbranch_scc0 Ll020
    s_sub_u32 s59, 2, s27
    s_lshl_b32 s59, s59, 14
    v_add_u32 v55, s59, v10
    global_load_dwordx4 v[176:179], v55, s[22:23] offset:-4096 sc1
    global_load_dwordx4 v[180:183], v55, s[22:23] offset:-2048 sc1
    global_load_dwordx4 v[184:187], v55, s[22:23] offset:0 sc1
    global_load_dwordx4 v[188:191], v55, s[22:23] offset:2048 sc1
Ll020:
    s_barrier
    ds_read_b64_tr_b16 v[160:161], v54 offset:0
    ds_read_b64_tr_b16 v[162:163], v54 offset:512
    ds_read_b64_tr_b16 v[164:165], v54 offset:4096
    ds_read_b64_tr_b16 v[166:167], v54 offset:4608
    s_cmp_eq_u32 s46, 0
    s_cbranch_scc1 Ll021
    s_sleep 6
Ll021:
    s_mov_b32 s47, 200000
    s_sleep 2
Lpoll22:
    global_load_dwordx4 v[32:35], v17, s[50:51] offset:0 sc1
    global_load_dwordx4 v[36:39], v17, s[50:51] offset:512 sc1
    global_load_dwordx4 v[40:43], v17, s[50:51] offset:1024 sc1
    global_load_dwordx4 v[44:47], v17, s[50:51] offset:1536 sc1
Lbody25:
    s_waitcnt vmcnt(2)
    v_xor_b32 v32, s43, v32
    v_xor_b32 v36, s43, v36
    v_or_b32 v48, v32, v36
    v_pk_add_f32 v[32:33], v[32:33], v[36:37]
    v_pk_add_f32 v[34:35], v[34:35], v[38:39]
    s_waitcnt vmcnt(0)
    v_xor_b32 v40, s43, v40
    v_xor_b32 v44, s43, v44
    v_or3_b32 v48, v48, v40, v44
    v_cmp_ne_u32_sdwa vcc, v48, 0 src0_sel:BYTE_0 src1_sel:DWORD
    s_cbranch_vccnz Lretry23
Lok24:
    v_pk_add_f32 v[40:41], v[40:41], v[44:45]
    v_pk_add_f32 v[42:43], v[42:43], v[46:47]
    v_pk_add_f32 v[32:33], v[32:33], v[40:41]
    v_pk_add_f32 v[34:35], v[34:35], v[42:43]
    s_nop 1
    v_permlane32_swap_b32 v32, v34
    v_permlane32_swap_b32 v33, v35
    v_add_f32 v32, v32, v34
    v_add_f32 v33, v33, v35
    s_nop 1
    v_permlane16_swap_b32 v32, v33
    v_add_f32 v32, v32, v33
    s_nop 1
    v_add_f32_dpp v32, v32, v32 row_ror:8 row_mask:0xf bank_mask:0xf
    v_add_f32 v32, v32, v3
    v_cvt_pk_bf16_f32 v32, v32, v32
    ds_write_b16 v29, v32
    v_and_b32 v3, 0xffff0000, v32
    s_cmp_eq_u32 s45, 0
    s_waitcnt lgkmcnt(0)
    s_barrier
    ds_read_b128 v[32:35], v30
    ds_read_b128 v[36:39], v30 offset:64
    s_waitcnt lgkmcnt(1)
    v_mfma_f32_16x16x32_bf16 v[40:43], v[32:35], v[160:163], 0
    s_waitcnt lgkmcnt(0)
    v_mfma_f32_16x16x32_bf16 v[40:43], v[36:39], v[164:167], v[40:43]
    s_mov_b32 exec_hi, 0xffff
    s_nop 6
    v_and_or_b32 v40, v40, v57, v58
    s_cbranch_scc1 Lslow26
    global_store_dword v18, v40, s[22:23]
Lback27:
    s_mov_b64 exec, -1
    s_mov_b32 s47, 200000
    s_waitcnt vmcnt(0)
    s_sleep 1
Lpoll28:
    global_load_dwordx4 v[48:51], v21, s[22:23] sc1
    global_load_dwordx4 v[32:35], v62, s[22:23] offset:-2048 sc1
    global_load_dwordx4 v[36:39], v20, s[22:23] offset:2048 sc1
Lbody31:
    s_waitcnt vmcnt(2)
    v_add_f32_dpp v44, v48, v48 row_ror:1 row_mask:0xf bank_mask:0xf
    v_add_f32_dpp v45, v49, v49 row_ror:1 row_mask:0xf bank_mask:0xf
    v_bitop3_b32 v43, v50, v51, v60 bitop3:0x7e
    v_add_f32_dpp v44, v44, v44 row_ror:2 row_mask:0xf bank_mask:0xf
    v_add_f32_dpp v45, v45, v45 row_ror:2 row_mask:0xf bank_mask:0xf
    s_nop 0
    v_add_f32_dpp v44, v44, v44 row_ror:4 row_mask:0xf bank_mask:0xf
    v_add_f32_dpp v45, v45, v45 row_ror:4 row_mask:0xf bank_mask:0xf
    v_mul_f32 v52, 0x3b000000, v45
    v_fmaak_f32 v44, v148, v44, 0x3727c5ac
    v_fma_f32 v44, -v52, v52, v44
    v_max_f32 v44, 0x3727c5ac, v44
    v_rsq_f32 v53, v44
    s_nop 0
    v_mul_f32 v46, 0xbfb8aa3b, v53
    s_waitcnt vmcnt(0)
    v_xor_b32 v32, s43, v32
    v_xor_b32 v36, s43, v36
    v_or_b32 v40, v32, v36
    v_and_or_b32 v40, v40, s6, v43
    v_cmp_ne_u32 vcc, 0, v40
    s_cbranch_vccnz Lretry29
Lok30:
    v_permlane32_swap_b32 v32, v34
    v_permlane32_swap_b32 v36, v38
    v_permlane32_swap_b32 v33, v35
    v_permlane32_swap_b32 v37, v39
    v_add_f32 v32, v32, v34
    v_add_f32 v36, v36, v38
    v_add_f32 v33, v33, v35
    v_add_f32 v37, v37, v39
    s_nop 0
    v_permlane16_swap_b32 v32, v33
    v_permlane16_swap_b32 v36, v37
    v_add_f32 v32, v32, v33
    v_add_f32 v36, v36, v37
    s_nop 0
    v_add_f32_dpp v32, v32, v32 row_ror:8 row_mask:0xf bank_mask:0xf
    v_add_f32_dpp v36, v36, v36 row_ror:8 row_mask:0xf bank_mask:0xf
    v_fma_f32 v32, -v52, v36, v32
    v_mul_f32 v33, v32, v46
    v_exp_f32 v33, v33
    v_mul_f32 v32, v32, v53
    v_add_f32 v33, 1.0, v33
    v_rcp_f32 v33, v33
    s_nop 0
    v_mul_f32 v32, v32, v33
    v_cvt_pk_bf16_f32 v32, v32, v32
    v_and_b32 v32, s62, v32
    ds_write_b16 v29, v32 offset:576
    s_waitcnt lgkmcnt(0)
    s_barrier
    s_or_b32 s59, s25, s42
    s_mul_i32 s59, s59, s46
    s_cmp_lg_u32 s59, 0
    s_cbranch_scc1 Lfin
    s_cmp_eq_u32 s46, 0
    s_cbranch_scc0 Ll032
    s_mov_b32 s47, 200000
Lcsp:
    v_bitop3_b32 v48, v176, v180, v2 bitop3:0x7e
    v_bitop3_b32 v49, v184, v188, v2 bitop3:0x7e
    v_or_b32 v48, v48, v49
    v_and_b32 v48, 0xff, v48
    v_cmp_ne_u32 vcc, 0, v48
    s_cbranch_vccz Lcsk
    global_load_dwordx4 v[176:179], v55, s[22:23] offset:-4096 sc1
    global_load_dwordx4 v[180:183], v55, s[22:23] offset:-2048 sc1
    global_load_dwordx4 v[184:187], v55, s[22:23] offset:0 sc1
    global_load_dwordx4 v[188:191], v55, s[22:23] offset:2048 sc1
    s_waitcnt vmcnt(0)
    s_sub_u32 s47, s47, 1
    s_cbranch_scc0 Lcsp
Lcsk:
    v_xor_b32 v176, s43, v176
    v_xor_b32 v180, s43, v180
    v_xor_b32 v184, s43, v184
    v_xor_b32 v188, s43, v188
    v_pk_add_f32 v[32:33], v[176:177], v[180:181]
    v_pk_add_f32 v[34:35], v[178:179], v[182:183]
    v_pk_add_f32 v[32:33], v[32:33], v[184:185]
    v_pk_add_f32 v[34:35], v[34:35], v[186:187]
    v_pk_add_f32 v[32:33], v[32:33], v[188:189]
    v_pk_add_f32 v[34:35], v[34:35], v[190:191]
    s_nop 1
    v_permlane32_swap_b32 v32, v34
    v_permlane32_swap_b32 v33, v35
    v_pk_add_f32 v[4:5], v[32:33], v[34:35]
Ll032:
    v_and_b32 v47, 0xffffff80, v31
    s_lshl_b32 s59, s3, 5
    v_add3_u32 v47, v47, v31, s59
    ds_read_b64_tr_b16 v[168:169], v47 offset:21760
    ds_read_b64_tr_b16 v[170:171], v47 offset:22784
    ds_read_b64_tr_b16 v[172:173], v47 offset:29952
    ds_read_b64_tr_b16 v[174:175], v47 offset:30976
    v_subrev_u32 v149, 1296, v29
    s_lshr_b32 s59, s3, 1
    s_mul_i32 s59, s59, 832
    s_lshl_b32 s60, s41, 7
    s_add_u32 s59, s59, s60
    v_add_u32 v149, s59, v149
    s_cmp_eq_u32 s43, 0xff
    s_cselect_b32 s16, 0, s43
    s_add_u32 s16, s16, 1
    s_mul_i32 s17, s16, 0x01010101
    v_mov_b32 v151, s16
    v_bfi_b32 v151, v57, 0, v151
    v_mov_b32 v146, s17
    s_barrier
    s_mov_b32 s47, 200000
    s_sleep 8
Lpoll33:
    global_load_dwordx4 v[32:35], v17, s[52:53] offset:0 sc1
    global_load_dwordx4 v[36:39], v17, s[52:53] offset:512 sc1
    global_load_dwordx4 v[40:43], v17, s[52:53] offset:1024 sc1
    global_load_dwordx4 v[44:47], v17, s[52:53] offset:1536 sc1
Lbody36:
    s_waitcnt vmcnt(2)
    v_xor_b32 v32, s43, v32
    v_xor_b32 v36, s43, v36
    v_or_b32 v48, v32, v36
    v_pk_add_f32 v[32:33], v[32:33], v[36:37]
    v_pk_add_f32 v[34:35], v[34:35], v[38:39]
    s_waitcnt vmcnt(0)
    v_xor_b32 v40, s43, v40
    v_xor_b32 v44, s43, v44
    v_or3_b32 v48, v48, v40, v44
    v_cmp_ne_u32_sdwa vcc, v48, 0 src0_sel:BYTE_0 src1_sel:DWORD
    s_cbranch_vccnz Lretry34
Lok35:
    v_pk_add_f32 v[40:41], v[40:41], v[44:45]
    v_pk_add_f32 v[42:43], v[42:43], v[46:47]
    v_pk_add_f32 v[32:33], v[32:33], v[40:41]
    v_pk_add_f32 v[34:35], v[34:35], v[42:43]
    s_nop 1
    v_permlane32_swap_b32 v32, v34
    v_permlane32_swap_b32 v33, v35
    v_add_f32 v32, v32, v34
    v_add_f32 v33, v33, v35
    s_nop 1
    v_permlane16_swap_b32 v32, v33
    v_add_f32 v32, v32, v33
    s_nop 1
    v_add_f32_dpp v32, v32, v32 row_ror:8 row_mask:0xf bank_mask:0xf
    v_add_f32 v32, v32, v3
    v_cvt_pk_bf16_f32 v32, v32, v32
    ds_write_b16 v29, v32
    v_and_b32 v3, 0xffff0000, v32
    s_cmp_eq_u32 s46, 0
    s_cbranch_scc1 Lg8
    s_mov_b32 exec_lo, 0x00ff00ff
    s_mov_b32 exec_hi, 0x00ff00ff
    global_store_short v149, v32, s[20:21]
    s_mov_b64 exec, -1
    s_branch Lfin
Lg8:
    s_or_b32 s59, s3, s42
    s_cbranch_scc0 Lg8s
    s_cmp_eq_u32 s45, 0
    s_waitcnt lgkmcnt(0)
    s_barrier
    ds_read_b128 v[32:35], v30
    ds_read_b128 v[36:39], v30 offset:64
    s_waitcnt lgkmcnt(1)
    v_mfma_f32_16x16x32_bf16 v[40:43], v[32:35], v[168:171], 0
    s_waitcnt lgkmcnt(0)
    v_mfma_f32_16x16x32_bf16 v[40:43], v[36:39], v[172:175], v[40:43]
    s_mov_b32 exec_hi, 0
    s_nop 6
    v_and_or_b32 v40, v40, v57, v151
    s_cbranch_scc1 Lslow37
    global_store_dword v23, v40, s[22:23]
Lback38:
    s_mov_b64 exec, -1
    s_branch Lg9
Lg8s:
    s_cmp_eq_u32 s45, 0
    s_waitcnt lgkmcnt(0)
    s_barrier
    ds_read_b128 v[32:35], v30
    ds_read_b128 v[36:39], v30 offset:64
    s_waitcnt lgkmcnt(1)
    v_mfma_f32_16x16x32_bf16 v[40:43], v[32:35], v[168:171], 0
    v_mfma_f32_16x16x32_bf16 v[44:47], v[32:35], v[32:35], 0
    s_waitcnt lgkmcnt(0)
    v_mfma_f32_16x16x32_bf16 v[40:43], v[36:39], v[172:175], v[40:43]
    v_mfma_f32_16x16x32_bf16 v[44:47], v[36:39], v[36:39], v[44:47]
    s_mov_b32 exec_hi, 0
    s_nop 4
    v_and_or_b32 v40, v40, v57, v151
    s_cbranch_scc1 Lslow39
    global_store_dword v23, v40, s[22:23]
Lback40:
    s_mov_b64 vcc, 0x01100101
    s_mov_b64 exec, 0x01160107
    v_cndmask_b32 v144, v146, v44, vcc
    s_cbranch_scc1 Lslow41
    global_store_dword v19, v144, s[22:23]
Lback42:
    s_mov_b64 exec, -1
Lg9:
    s_mov_b32 s43, s16
    v_mov_b32 v2, s16
    v_mov_b32 v60, s17
    v_mov_b32 v58, v151
    s_add_u32 s50, s50, 524288
    s_addc_u32 s51, s51, 0
    s_add_u32 s52, s52, 524288
    s_addc_u32 s53, s53, 0
    s_mov_b32 s46, 1
    v_mov_b32 v128, 0
    v_mov_b32 v129, 0
    v_mov_b32 v130, 0
    v_mov_b32 v131, 0
    v_mov_b32 v132, 0
    v_mov_b32 v133, 0
    v_mov_b32 v134, 0
    v_mov_b32 v135, 0
    v_mov_b32 v136, 0
    v_mov_b32 v137, 0
    v_mov_b32 v138, 0
    v_mov_b32 v139, 0
    v_mov_b32 v140, 0
    v_mov_b32 v141, 0
    v_mov_b32 v142, 0
    v_mov_b32 v143, 0
    s_waitcnt vmcnt(0)
    s_sleep 1
    s_branch LAG
Lfin:
Lexit:
    s_endpgm
Lfb:
    v_mfma_f32_16x16x32_bf16 v[176:179], a[0:3], v[160:163], 0
    v_mfma_f32_16x16x32_bf16 v[176:179], a[4:7], v[164:167], v[176:179]
    v_mfma_f32_16x16x32_bf16 v[176:179], a[8:11], v[168:171], v[176:179]
    v_mfma_f32_16x16x32_bf16 v[176:179], a[12:15], v[172:175], v[176:179]
    v_mfma_f32_16x16x32_bf16 v[180:183], a[16:19], v[160:163], 0
    v_mfma_f32_16x16x32_bf16 v[180:183], a[20:23], v[164:167], v[180:183]
    v_mfma_f32_16x16x32_bf16 v[180:183], a[24:27], v[168:171], v[180:183]
    v_mfma_f32_16x16x32_bf16 v[180:183], a[28:31], v[172:175], v[180:183]
    v_mfma_f32_16x16x32_bf16 v[184:187], a[32:35], v[160:163], 0
    v_mfma_f32_16x16x32_bf16 v[184:187], a[36:39], v[164:167], v[184:187]
    v_mfma_f32_16x16x32_bf16 v[184:187], a[40:43], v[168:171], v[184:187]
    v_mfma_f32_16x16x32_bf16 v[184:187], a[44:47], v[172:175], v[184:187]
    v_mfma_f32_16x16x32_bf16 v[188:191], a[48:51], v[160:163], 0
    v_mfma_f32_16x16x32_bf16 v[188:191], a[52:55], v[164:167], v[188:191]
    v_mfma_f32_16x16x32_bf16 v[188:191], a[56:59], v[168:171], v[188:191]
    v_mfma_f32_16x16x32_bf16 v[188:191], a[60:63], v[172:175], v[188:191]
    v_max3_f32 v32, v176, v177, v178
    v_max3_f32 v32, v32, v179, v180
    v_max3_f32 v32, v32, v181, v182
    v_max3_f32 v32, v32, v183, v184
    v_max3_f32 v32, v32, v185, v186
    s_nop 2
    v_max3_f32 v32, v32, v187, v188
    v_max3_f32 v32, v32, v189, v190
    v_max_f32 v32, v32, v191
    v_mov_b32 v33, v32
    s_nop 1
    v_permlane32_swap_b32 v32, v33
    v_max_f32 v32, v32, v33
    v_mov_b32 v33, v32
    s_nop 1
    v_permlane16_swap_b32 v32, v33
    v_max_f32 v44, v32, v33
    v_mov_b32 v45, 1
    v_mov_b32 v46, 0
    s_lshl_b32 s59, s3, 2
    v_add_u32 v47, s59, v28
    s_mov_b64 exec, 0xf
    ds_write_b32 v47, v44 offset:0
    ds_write_b32 v46, v45 offset:128
    s_mov_b64 exec, -1
    v_sub_f32 v176, v176, v44
    v_sub_f32 v177, v177, v44
    v_sub_f32 v178, v178, v44
    v_sub_f32 v179, v179, v44
    v_sub_f32 v180, v180, v44
    v_sub_f32 v181, v181, v44
    v_sub_f32 v182, v182, v44
    v_sub_f32 v183, v183, v44
    v_sub_f32 v184, v184, v44
    v_sub_f32 v185, v185, v44
    v_sub_f32 v186, v186, v44
    v_sub_f32 v187, v187, v44
    v_sub_f32 v188, v188, v44
    v_sub_f32 v189, v189, v44
    v_sub_f32 v190, v190, v44
    v_sub_f32 v191, v191, v44
    v_mov_b32 v128, 0
    v_mov_b32 v129, 0
    v_mov_b32 v130, 0
    v_mov_b32 v131, 0
    v_mov_b32 v132, 0
    v_mov_b32 v133, 0
    v_mov_b32 v134, 0
    v_mov_b32 v135, 0
    v_mov_b32 v136, 0
    v_mov_b32 v137, 0
    v_mov_b32 v138, 0
    v_mov_b32 v139, 0
    v_mov_b32 v140, 0
    v_mov_b32 v141, 0
    v_mov_b32 v142, 0
    v_mov_b32 v143, 0
    s_mov_b32 vcc_lo, 0xf0f0f0f0
    s_mov_b32 vcc_hi, 0xf0f0f0f0
    v_cndmask_b32 v176, v176, v178, vcc
    v_cndmask_b32 v177, v177, v179, vcc
    v_exp_f32 v176, v176
    v_exp_f32 v177, v177
    v_cndmask_b32 v180, v180, v182, vcc
    v_cndmask_b32 v181, v181, v183, vcc
    v_exp_f32 v180, v180
    v_exp_f32 v181, v181
    v_cndmask_b32 v184, v184, v186, vcc
    v_cndmask_b32 v185, v185, v187, vcc
    v_exp_f32 v184, v184
    v_exp_f32 v185, v185
    v_cndmask_b32 v188, v188, v190, vcc
    v_cndmask_b32 v189, v189, v191, vcc
    v_exp_f32 v188, v188
    v_exp_f32 v189, v189
    s_mov_b64 exec, s[8:9]
    v_cvt_pk_bf16_f32 v152, v176, v177
    v_cvt_pk_bf16_f32 v153, v180, v181
    v_cvt_pk_bf16_f32 v154, v184, v185
    v_cvt_pk_bf16_f32 v155, v188, v189
    s_not_b64 exec, exec
    v_cvt_pk_bf16_f32 v156, v176, v177
    v_cvt_pk_bf16_f32 v157, v180, v181
    v_cvt_pk_bf16_f32 v158, v184, v185
    v_cvt_pk_bf16_f32 v159, v188, v189
    s_mov_b64 exec, -1
    v_smfmac_f32_16x16x64_bf16 v[128:131], v[152:155], v[64:71], v7
    v_smfmac_f32_16x16x64_bf16 v[132:135], v[152:155], v[72:79], v7
    v_smfmac_f32_16x16x64_bf16 v[136:139], v[152:155], v[96:103], v7
    v_smfmac_f32_16x16x64_bf16 v[140:143], v[152:155], v[104:111], v7
    v_smfmac_f32_16x16x64_bf16 v[128:131], v[156:159], v[80:87], v7
    v_smfmac_f32_16x16x64_bf16 v[132:135], v[156:159], v[88:95], v7
    v_smfmac_f32_16x16x64_bf16 v[136:139], v[156:159], v[112:119], v7
    v_smfmac_f32_16x16x64_bf16 v[140:143], v[156:159], v[120:127], v7
    v_add_f32 v36, v176, v177
    v_add_f32 v37, v180, v181
    v_add_f32 v38, v184, v185
    v_add_f32 v36, v36, v37
    v_add_f32 v39, v188, v189
    v_add_f32 v36, v36, v38
    v_add_f32 v36, v36, v39
    ds_write_b32 v8, v36 offset:3328
    s_cmp_lt_u32 s3, 4
    s_branch Lfbback
Lsc:
    v_lshrrev_b32 v36, 5, v1
    v_lshlrev_b32 v36, 4, v36
    ds_read_b128 v[160:163], v36 offset:0
    ds_read_b128 v[164:167], v36 offset:32
    ds_read_b128 v[168:171], v36 offset:64
    ds_read_b128 v[172:175], v36 offset:96
    s_waitcnt lgkmcnt(0)
    v_max3_f32 v37, v160, v161, v162
    v_max_f32 v37, v37, v163
    v_mov_b32 v38, v37
    s_nop 1
    v_permlane32_swap_b32 v37, v38
    v_max_f32 v37, v37, v38
    v_and_b32 v37, s44, v37
    v_sub_f32 v160, v160, v37
    v_exp_f32 v160, v160
    v_sub_f32 v161, v161, v37
    v_exp_f32 v161, v161
    v_sub_f32 v162, v162, v37
    v_exp_f32 v162, v162
    v_sub_f32 v163, v163, v37
    v_exp_f32 v163, v163
    v_mul_f32 v32, v160, v128
    v_fmac_f32 v32, v161, v132
    v_fmac_f32 v32, v162, v136
    v_fmac_f32 v32, v163, v140
    v_max3_f32 v37, v164, v165, v166
    v_max_f32 v37, v37, v167
    v_mov_b32 v38, v37
    s_nop 1
    v_permlane32_swap_b32 v37, v38
    v_max_f32 v37, v37, v38
    v_and_b32 v37, s44, v37
    v_sub_f32 v164, v164, v37
    v_exp_f32 v164, v164
    v_sub_f32 v165, v165, v37
    v_exp_f32 v165, v165
    v_sub_f32 v166, v166, v37
    v_exp_f32 v166, v166
    v_sub_f32 v167, v167, v37
    v_exp_f32 v167, v167
    v_mul_f32 v33, v164, v129
    v_fmac_f32 v33, v165, v133
    v_fmac_f32 v33, v166, v137
    v_fmac_f32 v33, v167, v141
    v_max3_f32 v37, v168, v169, v170
    v_max_f32 v37, v37, v171
    v_mov_b32 v38, v37
    s_nop 1
    v_permlane32_swap_b32 v37, v38
    v_max_f32 v37, v37, v38
    v_and_b32 v37, s44, v37
    v_sub_f32 v168, v168, v37
    v_exp_f32 v168, v168
    v_sub_f32 v169, v169, v37
    v_exp_f32 v169, v169
    v_sub_f32 v170, v170, v37
    v_exp_f32 v170, v170
    v_sub_f32 v171, v171, v37
    v_exp_f32 v171, v171
    v_mul_f32 v34, v168, v130
    v_fmac_f32 v34, v169, v134
    v_fmac_f32 v34, v170, v138
    v_fmac_f32 v34, v171, v142
    v_max3_f32 v37, v172, v173, v174
    v_max_f32 v37, v37, v175
    v_mov_b32 v38, v37
    s_nop 1
    v_permlane32_swap_b32 v37, v38
    v_max_f32 v37, v37, v38
    v_and_b32 v37, s44, v37
    v_sub_f32 v172, v172, v37
    v_exp_f32 v172, v172
    v_sub_f32 v173, v173, v37
    v_exp_f32 v173, v173
    v_sub_f32 v174, v174, v37
    v_exp_f32 v174, v174
    v_sub_f32 v175, v175, v37
    v_exp_f32 v175, v175
    v_mul_f32 v35, v172, v131
    v_fmac_f32 v35, v173, v135
    v_fmac_f32 v35, v174, v139
    v_fmac_f32 v35, v175, v143
    s_nop 0
    s_branch Lscback
Lsl:
    ds_read_b128 v[160:163], v28 offset:0
    ds_read_b128 v[164:167], v28 offset:16
    s_waitcnt lgkmcnt(0)
    v_max3_f32 v168, v160, v161, v162
    v_max3_f32 v168, v168, v163, v164
    v_max3_f32 v168, v168, v165, v166
    v_max_f32 v168, v168, v167
    v_and_b32 v168, s44, v168
    v_sub_f32 v160, v160, v168
    v_sub_f32 v161, v161, v168
    v_sub_f32 v162, v162, v168
    v_sub_f32 v163, v163, v168
    v_sub_f32 v164, v164, v168
    v_sub_f32 v165, v165, v168
    v_sub_f32 v166, v166, v168
    v_sub_f32 v167, v167, v168
    v_exp_f32 v160, v160
    v_exp_f32 v161, v161
    v_exp_f32 v162, v162
    v_exp_f32 v163, v163
    v_exp_f32 v164, v164
    v_exp_f32 v165, v165
    v_exp_f32 v166, v166
    v_exp_f32 v167, v167
    v_or_b32 v48, v168, v2
    v_mul_f32 v49, v160, v32
    v_fmac_f32 v49, v161, v33
    v_fmac_f32 v49, v162, v34
    v_fmac_f32 v49, v163, v35
    v_fmac_f32 v49, v164, v36
    v_fmac_f32 v49, v165, v37
    v_fmac_f32 v49, v166, v38
    v_fmac_f32 v49, v167, v39
    s_nop 0
    s_branch Lslback
Loslow:
    v_and_b32 v48, s44, v48
    v_and_b32 v49, s7, v49
    s_nop 0
    v_max_f32_dpp v50, v48, v48 row_ror:4 row_mask:0xf bank_mask:0xf
    s_nop 1
    v_max_f32_dpp v50, v50, v50 row_ror:8 row_mask:0xf bank_mask:0xf
    v_mov_b32 v51, v50
    s_nop 1
    v_permlane16_swap_b32 v50, v51
    v_max_f32 v50, v50, v51
    v_mov_b32 v51, v50
    s_nop 1
    v_permlane32_swap_b32 v50, v51
    v_max_f32 v50, v50, v51
    v_sub_f32 v48, v48, v50
    v_exp_f32 v48, v48
    s_nop 0
    v_mul_f32 v49, v49, v48
    s_nop 1
    v_add_f32_dpp v49, v49, v49 row_ror:4 row_mask:0xf bank_mask:0xf
    s_nop 1
    v_add_f32_dpp v49, v49, v49 row_ror:8 row_mask:0xf bank_mask:0xf
    v_mov_b32 v51, v49
    s_nop 1
    v_permlane16_swap_b32 v49, v51
    v_add_f32 v49, v49, v51
    v_mov_b32 v51, v49
    s_nop 1
    v_permlane32_swap_b32 v49, v51
    v_add_f32 v49, v49, v51
    v_rcp_f32 v49, v49
    v_mul_f32_dpp v160, v48, v32 row_newbcast:0 row_mask:0xf bank_mask:0xf
    v_mul_f32_dpp v161, v48, v33 row_newbcast:1 row_mask:0xf bank_mask:0xf
    v_mul_f32_dpp v162, v48, v34 row_newbcast:2 row_mask:0xf bank_mask:0xf
    v_mul_f32_dpp v163, v48, v35 row_newbcast:3 row_mask:0xf bank_mask:0xf
    v_fmac_f32_dpp v160, v48, v36 row_newbcast:4 row_mask:0xf bank_mask:0xf
    v_fmac_f32_dpp v161, v48, v37 row_newbcast:5 row_mask:0xf bank_mask:0xf
    v_fmac_f32_dpp v162, v48, v38 row_newbcast:6 row_mask:0xf bank_mask:0xf
    v_fmac_f32_dpp v163, v48, v39 row_newbcast:7 row_mask:0xf bank_mask:0xf
    v_fmac_f32_dpp v160, v48, v40 row_newbcast:8 row_mask:0xf bank_mask:0xf
    v_fmac_f32_dpp v161, v48, v41 row_newbcast:9 row_mask:0xf bank_mask:0xf
    v_fmac_f32_dpp v162, v48, v42 row_newbcast:10 row_mask:0xf bank_mask:0xf
    v_fmac_f32_dpp v163, v48, v43 row_newbcast:11 row_mask:0xf bank_mask:0xf
    v_fmac_f32_dpp v160, v48, v44 row_newbcast:12 row_mask:0xf bank_mask:0xf
    v_fmac_f32_dpp v161, v48, v45 row_newbcast:13 row_mask:0xf bank_mask:0xf
    v_fmac_f32_dpp v162, v48, v46 row_newbcast:14 row_mask:0xf bank_mask:0xf
    v_fmac_f32_dpp v163, v48, v47 row_newbcast:15 row_mask:0xf bank_mask:0xf
    v_mul_f32_dpp v32, v49, v160 quad_perm:[0,0,0,0] row_mask:0xf bank_mask:0xf
    v_mul_f32_dpp v33, v49, v161 quad_perm:[1,1,1,1] row_mask:0xf bank_mask:0xf
    v_mul_f32_dpp v34, v49, v162 quad_perm:[2,2,2,2] row_mask:0xf bank_mask:0xf
    v_mul_f32_dpp v35, v49, v163 quad_perm:[3,3,3,3] row_mask:0xf bank_mask:0xf
    s_nop 0
    v_permlane32_swap_b32 v32, v34
    v_permlane32_swap_b32 v33, v35
    v_add_f32 v32, v32, v34
    v_add_f32 v33, v33, v35
    s_nop 1
    v_permlane16_swap_b32 v32, v33
    v_add_f32 v32, v32, v33
    s_nop 0
    s_branch Loback
Lretry2:
    s_sub_u32 s47, s47, 1
    s_nop 1
    s_cbranch_scc0 Lpoll1
    s_branch Lok3
Lretry16:
    s_sub_u32 s47, s47, 1
    s_nop 1
    s_cbranch_scc0 Lpoll15
    s_branch Lok17
Lretry23:
    s_sub_u32 s47, s47, 1
    s_nop 1
    s_cbranch_scc0 Lpoll22
    s_branch Lok24
Lretry29:
    s_sub_u32 s47, s47, 1
    s_nop 1
    s_cbranch_scc0 Lpoll28
    s_branch Lok30
Lretry34:
    s_sub_u32 s47, s47, 1
    s_nop 1
    s_cbranch_scc0 Lpoll33
    s_branch Lok35
Lslow5:
    global_store_dwordx2 v12, v[32:33], s[22:23] sc1
    s_branch Lback6
Lslow9:
    global_store_dword v19, v144, s[22:23] sc1
    s_branch Lback10
Lslow11:
    global_store_dword v23, v40, s[22:23] sc1
    s_branch Lback12
Lslow13:
    global_store_dwordx2 v13, v[48:49], s[22:23] sc1
    s_branch Lback14
Lslow26:
    global_store_dword v18, v40, s[22:23] sc1
    s_branch Lback27
Lslow37:
    global_store_dword v23, v40, s[22:23] sc1
    s_branch Lback38
Lslow39:
    global_store_dword v23, v40, s[22:23] sc1
    s_branch Lback40
Lslow41:
    global_store_dword v19, v144, s[22:23] sc1
    s_branch Lback42
.section .rodata,"a"
.p2align 6
.amdhsa_kernel interleave_layers__gqa_block_cached__dense_activation_silu__decode_kernel
  .amdhsa_next_free_vgpr 256
  .amdhsa_next_free_sgpr 102
  .amdhsa_accum_offset 192
  .amdhsa_group_segment_fixed_size 0
  .amdhsa_kernarg_size 88
  .amdhsa_user_sgpr_count 2
  .amdhsa_user_sgpr_kernarg_segment_ptr 1
  .amdhsa_system_sgpr_workgroup_id_x 1
.end_amdhsa_kernel
```
